```python
import torch

def _softmax(x, axis=-1):
    return torch.softmax(x, dim=axis)
def _gelu(x):
    return torch.nn.functional.gelu(x, approximate="tanh")
def _silu(x):
    return torch.nn.functional.silu(x)
def _sigmoid(x):
    return torch.sigmoid(x)
def _layernorm(x, axis=-1, eps=1e-5):
    m = x.mean(dim=axis, keepdim=True)
    v = x.var(dim=axis, keepdim=True, unbiased=False)
    return (x - m) / torch.sqrt(v + eps)
def _scatter_add(tgt, idx, src, axis=0):
    return tgt.clone().index_add_(axis, idx, src)
def _segment_sum(src, seg, n):
    out = torch.zeros((n,) + src.shape[1:], dtype=src.dtype)
    return out.index_add_(0, seg, src)
def _pad(x, pw):
    flat = tuple(v for pair in reversed(pw) for v in pair)
    return torch.nn.functional.pad(x, flat)

kernel_name = 'recurrent_scan__ssm_conv_s4d__geglu_ffn__prompt'

def setup_inputs():

    _w = (lambda a: (lambda t: t.to(torch.bfloat16) if t.is_floating_point() else t)(torch.as_tensor(a)))
    def _A_setup():
        Bsz, L, D, N = 1, 2048, 512, 128
        return {
            "u": _w((lambda *s: torch.randn(*s, dtype=torch.bfloat16) * 0.05)(Bsz, L, D)),
            "log_A_real": _w((lambda *s: torch.randn(*s, dtype=torch.bfloat16) * 6.4)(D, N) * 0.5),
            "A_imag": _w((lambda *s: torch.randn(*s, dtype=torch.bfloat16) * 0.05)(D, N) * 3.14),
            "C_real": _w((lambda *s: torch.randn(*s, dtype=torch.bfloat16) * 0.05)(D, N) / N ** 0.5),
            "C_imag": _w((lambda *s: torch.randn(*s, dtype=torch.bfloat16) * 0.05)(D, N) / N ** 0.5),
            "log_dt": _w((lambda *s: torch.randn(*s, dtype=torch.bfloat16) * 0.05)(D) * 0.5 - 4.0),
            "D_skip": _w((lambda *s: torch.randn(*s, dtype=torch.bfloat16) * 0.05)(D)),
        }
    _A_in = _A_setup()

    def _B_setup():
        B, S, D, F = 1, 2048, 512, 1792
        return {
            "x": _w((lambda *s: torch.randn(*s, dtype=torch.bfloat16) * 0.05)(B, S, D)),
            "w_gate": _w((lambda *s: torch.randn(*s, dtype=torch.bfloat16) * 0.05)(D, F)),
            "w_up": _w((lambda *s: torch.randn(*s, dtype=torch.bfloat16) * 0.05)(D, F)),
            "w_down": _w((lambda *s: torch.randn(*s, dtype=torch.bfloat16) * 0.05)(F, D)),
        }
    _B_in = _B_setup()

    return {
        "A_u": _A_in["u"],
        "A_log_A_real": _A_in["log_A_real"],
        "A_A_imag": _A_in["A_imag"],
        "A_C_real": _A_in["C_real"],
        "A_C_imag": _A_in["C_imag"],
        "A_log_dt": _A_in["log_dt"],
        "A_D_skip": _A_in["D_skip"],
        "B_x": _B_in["x"],
        "B_w_gate": _B_in["w_gate"],
        "B_w_up": _B_in["w_up"],
        "B_w_down": _B_in["w_down"],
    }

def reference(A_u, A_log_A_real, A_A_imag, A_C_real, A_C_imag, A_log_dt, A_D_skip, B_x, B_w_gate, B_w_up, B_w_down):
    def _A_ref(u, log_A_real, A_imag, C_real, C_imag, log_dt, D_skip):
        L = u.shape[1]
        dt = torch.exp(log_dt)
        A = -torch.exp(log_A_real) + 1j * A_imag
        C = (C_real + 1j * C_imag) * dt[:, None]
        pos = (lambda x, dt: x.to(dt))(torch.arange(L), log_dt.dtype)
        P = torch.exp((A * dt[:, None])[:, :, None] * pos[None, None, :])
        K = 2.0 * torch.einsum("dn,dnl->dl", C, P).real
        L2 = 2 * L
        u_t = (lambda x, *d: x.permute(*d))(u, 0, 2, 1)
        Kf = (lambda x, *a, **k: torch.fft.rfft(x.float(), *a, **k))(K, L2)
        Uf = (lambda x, *a, **k: torch.fft.rfft(x.float(), *a, **k))(u_t, L2)
        y = (lambda x, *a, **k: torch.fft.irfft(x, *a, **k).to(torch.bfloat16))(Uf * Kf[None, :, :], L2)[:, :, :L]
        y = (lambda x, *d: x.permute(*d))(y, 0, 2, 1)
        return y + u * D_skip[None, None, :]

    def _B_ref(x, w_gate, w_up, w_down):
        return (_gelu(x @ w_gate) * (x @ w_up)) @ w_down

    x = A_u
    xn = _layernorm(x, axis=-1)
    s = _A_ref(xn, A_log_A_real, A_A_imag, A_C_real, A_C_imag, A_log_dt, A_D_skip)
    g = _silu(_B_ref(xn, B_w_gate, B_w_up, B_w_down))
    return x + s * g
```

```asm
; @launch kernel=k1_kernel grid=(256,1,1) block=(256,1,1) lds=8448
; @launch kernel=k23_kernel grid=(256,1,1) block=(512,1,1) lds=162496
; @launch kernel=k4_kernel grid=(256,1,1) block=(256,1,1) lds=140288
.amdgcn_target "amdgcn-amd-amdhsa--gfx950"
.text
.globl k1_kernel
.p2align 8
.type k1_kernel,@function
k1_kernel:
    s_cmp_ge_u32 s2, 256
    s_cbranch_scc1 K1_END
    s_load_dwordx16 s[4:19], s[0:1], 0
    s_load_dwordx8 s[20:27], s[0:1], 64
    s_load_dwordx4 s[28:31], s[0:1], 96
    v_and_b32 v1, 63, v0
    v_lshrrev_b32 v2, 6, v0
    s_nop 0
    v_readfirstlane_b32 s32, v2
    v_and_b32 v3, 15, v1
    v_lshrrev_b32 v4, 4, v1
    v_lshlrev_b32 v5, 4, v1
    s_waitcnt lgkmcnt(0)
    s_mov_b32 s36, s4
    s_and_b32 s37, s5, 0xffff
    s_mov_b32 s38, 2097152
    s_mov_b32 s39, 0x00020000
    s_lshl_b32 s40, s2, 13
    s_lshl_b32 s33, s32, 11
    s_add_u32 s40, s40, s33
    buffer_load_dwordx4 v[8:11], v5, s[36:39], s40 offen offset:0
    buffer_load_dwordx4 v[12:15], v5, s[36:39], s40 offen offset:1024
    s_lshl_b32 s41, s2, 1
    s_lshr_b32 s33, s32, 1
    s_add_u32 s41, s41, s33
    s_and_b32 s42, s32, 1
    s_cmp_lt_u32 s32, 2
    s_cselect_b32 s44, s20, s22
    s_cselect_b32 s45, s21, s23
    s_and_b32 s45, s45, 0xffff
    s_mov_b32 s46, 1835008
    s_mov_b32 s47, 0x00020000
    s_and_b32 s48, s2, 7
    s_lshl_b32 s49, s42, 3
    s_add_u32 s48, s48, s49
    s_mul_i32 s48, s48, 224
    s_lshr_b32 s49, s2, 3
    s_mul_i32 s49, s49, 57344
    s_add_u32 s48, s48, s49
    v_min_u32 v16, 13, v3
    v_lshlrev_b32 v16, 4, v16
    v_mul_u32_u24 v20, 3584, v4
    v_add_u32 v16, v16, v20
    buffer_load_dwordx4 v[20:23], v16, s[44:47], s48 offen
    s_add_u32 s48, s48, 14336
    buffer_load_dwordx4 v[20:23], v16, s[44:47], s48 offen
    s_add_u32 s48, s48, 14336
    buffer_load_dwordx4 v[20:23], v16, s[44:47], s48 offen
    s_add_u32 s48, s48, 14336
    buffer_load_dwordx4 v[20:23], v16, s[44:47], s48 offen
    s_add_u32 s52, s30, 0
    s_addc_u32 s53, s31, 0
    s_and_b32 s53, s53, 0xffff
    s_mov_b32 s54, 2097152
    s_mov_b32 s55, 0x00020000
    s_add_u32 s56, s30, 2097152
    s_addc_u32 s57, s31, 0
    s_and_b32 s57, s57, 0xffff
    s_mov_b32 s58, 2129920
    s_mov_b32 s59, 0x00020000
    s_mov_b32 s60, 0x3f803f80
    s_mov_b32 s61, 0xffff0000
    s_waitcnt vmcnt(5)
    v_dot2_f32_bf16 v24, v8, s60, 0
    s_nop 2
    v_dot2_f32_bf16 v24, v9, s60, v24
    s_nop 2
    v_dot2_f32_bf16 v24, v10, s60, v24
    s_nop 2
    v_dot2_f32_bf16 v24, v11, s60, v24
    s_waitcnt vmcnt(4)
    v_dot2_f32_bf16 v25, v12, s60, 0
    s_nop 2
    v_dot2_f32_bf16 v25, v13, s60, v25
    s_nop 2
    v_dot2_f32_bf16 v25, v14, s60, v25
    s_nop 2
    v_dot2_f32_bf16 v25, v15, s60, v25
    v_add_f32_dpp v24, v24, v24 quad_perm:[1,0,3,2] row_mask:0xf bank_mask:0xf
    s_nop 1
    v_add_f32_dpp v25, v25, v25 quad_perm:[1,0,3,2] row_mask:0xf bank_mask:0xf
    v_add_f32_dpp v24, v24, v24 quad_perm:[2,3,0,1] row_mask:0xf bank_mask:0xf
    s_nop 0
    v_add_f32_dpp v25, v25, v25 quad_perm:[2,3,0,1] row_mask:0xf bank_mask:0xf
    v_add_f32_dpp v24, v24, v24 row_half_mirror row_mask:0xf bank_mask:0xf
    s_nop 0
    v_add_f32_dpp v25, v25, v25 row_half_mirror row_mask:0xf bank_mask:0xf
    v_add_f32_dpp v24, v24, v24 row_mirror row_mask:0xf bank_mask:0xf
    s_nop 0
    v_add_f32_dpp v25, v25, v25 row_mirror row_mask:0xf bank_mask:0xf
    v_mov_b32 v26, v24
    v_mov_b32 v27, v25
    s_nop 0
    v_permlane16_swap_b32 v24, v26
    v_permlane16_swap_b32 v25, v27
    v_add_f32 v24, v24, v26
    v_add_f32 v25, v25, v27
    v_mov_b32 v26, v24
    v_mov_b32 v27, v25
    s_nop 0
    v_permlane32_swap_b32 v24, v26
    v_permlane32_swap_b32 v25, v27
    v_add_f32 v24, v24, v26
    v_add_f32 v25, v25, v27
    v_mul_f32 v24, 0x3b000000, v24
    v_mul_f32 v25, 0x3b000000, v25
    v_lshlrev_b32 v28, 16, v8
    v_and_b32 v29, s61, v8
    v_lshlrev_b32 v30, 16, v9
    v_and_b32 v31, s61, v9
    v_lshlrev_b32 v32, 16, v10
    v_and_b32 v33, s61, v10
    v_lshlrev_b32 v34, 16, v11
    v_and_b32 v35, s61, v11
    v_lshlrev_b32 v36, 16, v12
    v_and_b32 v37, s61, v12
    v_lshlrev_b32 v38, 16, v13
    v_and_b32 v39, s61, v13
    v_lshlrev_b32 v40, 16, v14
    v_and_b32 v41, s61, v14
    v_lshlrev_b32 v42, 16, v15
    v_and_b32 v43, s61, v15
    v_sub_f32 v26, v28, v24
    v_sub_f32 v46, v29, v24
    v_sub_f32 v27, v36, v25
    v_sub_f32 v47, v37, v25
    v_mul_f32 v44, v26, v26
    v_mul_f32 v45, v27, v27
    v_fma_f32 v44, v46, v46, v44
    v_fma_f32 v45, v47, v47, v45
    v_sub_f32 v26, v30, v24
    v_sub_f32 v46, v31, v24
    v_sub_f32 v27, v38, v25
    v_sub_f32 v47, v39, v25
    v_fma_f32 v44, v26, v26, v44
    v_fma_f32 v45, v27, v27, v45
    v_fma_f32 v44, v46, v46, v44
    v_fma_f32 v45, v47, v47, v45
    v_sub_f32 v26, v32, v24
    v_sub_f32 v46, v33, v24
    v_sub_f32 v27, v40, v25
    v_sub_f32 v47, v41, v25
    v_fma_f32 v44, v26, v26, v44
    v_fma_f32 v45, v27, v27, v45
    v_fma_f32 v44, v46, v46, v44
    v_fma_f32 v45, v47, v47, v45
    v_sub_f32 v26, v34, v24
    v_sub_f32 v46, v35, v24
    v_sub_f32 v27, v42, v25
    v_sub_f32 v47, v43, v25
    v_fma_f32 v44, v26, v26, v44
    v_fma_f32 v45, v27, v27, v45
    v_fma_f32 v44, v46, v46, v44
    v_fma_f32 v45, v47, v47, v45
    s_nop 0
    v_add_f32_dpp v44, v44, v44 quad_perm:[1,0,3,2] row_mask:0xf bank_mask:0xf
    v_add_f32_dpp v45, v45, v45 quad_perm:[1,0,3,2] row_mask:0xf bank_mask:0xf
    s_nop 0
    v_add_f32_dpp v44, v44, v44 quad_perm:[2,3,0,1] row_mask:0xf bank_mask:0xf
    v_add_f32_dpp v45, v45, v45 quad_perm:[2,3,0,1] row_mask:0xf bank_mask:0xf
    s_nop 0
    v_add_f32_dpp v44, v44, v44 row_half_mirror row_mask:0xf bank_mask:0xf
    v_add_f32_dpp v45, v45, v45 row_half_mirror row_mask:0xf bank_mask:0xf
    s_nop 0
    v_add_f32_dpp v44, v44, v44 row_mirror row_mask:0xf bank_mask:0xf
    v_add_f32_dpp v45, v45, v45 row_mirror row_mask:0xf bank_mask:0xf
    v_mov_b32 v26, v44
    v_mov_b32 v27, v45
    s_nop 0
    v_permlane16_swap_b32 v44, v26
    v_permlane16_swap_b32 v45, v27
    v_add_f32 v44, v44, v26
    v_add_f32 v45, v45, v27
    v_mov_b32 v26, v44
    v_mov_b32 v27, v45
    s_nop 0
    v_permlane32_swap_b32 v44, v26
    v_permlane32_swap_b32 v45, v27
    v_add_f32 v44, v44, v26
    v_add_f32 v45, v45, v27
    v_mul_f32 v44, 0x3b000000, v44
    v_mul_f32 v45, 0x3b000000, v45
    v_cvt_pk_bf16_f32 v44, v44, v44
    v_lshlrev_b32 v44, 16, v44
    v_cvt_pk_bf16_f32 v45, v45, v45
    v_lshlrev_b32 v45, 16, v45
    v_add_f32 v44, 0x3727c5ac, v44
    v_add_f32 v45, 0x3727c5ac, v45
    v_cvt_pk_bf16_f32 v44, v44, v44
    v_lshlrev_b32 v44, 16, v44
    v_cvt_pk_bf16_f32 v45, v45, v45
    v_lshlrev_b32 v45, 16, v45
    v_sqrt_f32 v44, v44
    v_sqrt_f32 v45, v45
    v_cvt_pk_bf16_f32 v44, v44, v44
    v_lshlrev_b32 v44, 16, v44
    v_cvt_pk_bf16_f32 v45, v45, v45
    v_lshlrev_b32 v45, 16, v45
    v_rcp_f32 v48, v44
    v_rcp_f32 v49, v45
    v_cvt_pk_bf16_f32 v24, v24, v24
    v_lshlrev_b32 v24, 16, v24
    v_cvt_pk_bf16_f32 v25, v25, v25
    v_lshlrev_b32 v25, 16, v25
    v_mul_u32_u24 v50, 2112, v2
    v_add_u32 v50, v50, v5
    v_sub_f32 v56, v28, v24
    v_sub_f32 v57, v29, v24
    v_cvt_pk_bf16_f32 v57, v56, v57
    v_lshlrev_b32 v56, 16, v57
    v_and_b32 v57, s61, v57
    v_mul_f32 v58, v56, v48
    v_mul_f32 v59, v57, v48
    v_fma_f32 v60, -v58, v44, v56
    v_fma_f32 v61, -v59, v44, v57
    v_fma_f32 v58, v60, v48, v58
    v_fma_f32 v59, v61, v48, v59
    v_cvt_pk_bf16_f32 v8, v58, v59
    v_lshlrev_b32 v58, 16, v8
    v_and_b32 v59, s61, v8
    v_cvt_pkrtz_f16_f32 v52, v58, v59
    v_sub_f32 v56, v30, v24
    v_sub_f32 v57, v31, v24
    v_cvt_pk_bf16_f32 v57, v56, v57
    v_lshlrev_b32 v56, 16, v57
    v_and_b32 v57, s61, v57
    v_mul_f32 v58, v56, v48
    v_mul_f32 v59, v57, v48
    v_fma_f32 v60, -v58, v44, v56
    v_fma_f32 v61, -v59, v44, v57
    v_fma_f32 v58, v60, v48, v58
    v_fma_f32 v59, v61, v48, v59
    v_cvt_pk_bf16_f32 v9, v58, v59
    v_lshlrev_b32 v58, 16, v9
    v_and_b32 v59, s61, v9
    v_cvt_pkrtz_f16_f32 v53, v58, v59
    v_sub_f32 v56, v32, v24
    v_sub_f32 v57, v33, v24
    v_cvt_pk_bf16_f32 v57, v56, v57
    v_lshlrev_b32 v56, 16, v57
    v_and_b32 v57, s61, v57
    v_mul_f32 v58, v56, v48
    v_mul_f32 v59, v57, v48
    v_fma_f32 v60, -v58, v44, v56
    v_fma_f32 v61, -v59, v44, v57
    v_fma_f32 v58, v60, v48, v58
    v_fma_f32 v59, v61, v48, v59
    v_cvt_pk_bf16_f32 v10, v58, v59
    v_lshlrev_b32 v58, 16, v10
    v_and_b32 v59, s61, v10
    v_cvt_pkrtz_f16_f32 v54, v58, v59
    v_sub_f32 v56, v34, v24
    v_sub_f32 v57, v35, v24
    v_cvt_pk_bf16_f32 v57, v56, v57
    v_lshlrev_b32 v56, 16, v57
    v_and_b32 v57, s61, v57
    v_mul_f32 v58, v56, v48
    v_mul_f32 v59, v57, v48
    v_fma_f32 v60, -v58, v44, v56
    v_fma_f32 v61, -v59, v44, v57
    v_fma_f32 v58, v60, v48, v58
    v_fma_f32 v59, v61, v48, v59
    v_cvt_pk_bf16_f32 v11, v58, v59
    v_lshlrev_b32 v58, 16, v11
    v_and_b32 v59, s61, v11
    v_cvt_pkrtz_f16_f32 v55, v58, v59
    buffer_store_dwordx4 v[8:11], v5, s[52:55], s40 offen offset:0
    ds_write_b128 v50, v[52:55] offset:0
    v_sub_f32 v56, v36, v25
    v_sub_f32 v57, v37, v25
    v_cvt_pk_bf16_f32 v57, v56, v57
    v_lshlrev_b32 v56, 16, v57
    v_and_b32 v57, s61, v57
    v_mul_f32 v58, v56, v49
    v_mul_f32 v59, v57, v49
    v_fma_f32 v60, -v58, v45, v56
    v_fma_f32 v61, -v59, v45, v57
    v_fma_f32 v58, v60, v49, v58
    v_fma_f32 v59, v61, v49, v59
    v_cvt_pk_bf16_f32 v12, v58, v59
    v_lshlrev_b32 v58, 16, v12
    v_and_b32 v59, s61, v12
    v_cvt_pkrtz_f16_f32 v52, v58, v59
    v_sub_f32 v56, v38, v25
    v_sub_f32 v57, v39, v25
    v_cvt_pk_bf16_f32 v57, v56, v57
    v_lshlrev_b32 v56, 16, v57
    v_and_b32 v57, s61, v57
    v_mul_f32 v58, v56, v49
    v_mul_f32 v59, v57, v49
    v_fma_f32 v60, -v58, v45, v56
    v_fma_f32 v61, -v59, v45, v57
    v_fma_f32 v58, v60, v49, v58
    v_fma_f32 v59, v61, v49, v59
    v_cvt_pk_bf16_f32 v13, v58, v59
    v_lshlrev_b32 v58, 16, v13
    v_and_b32 v59, s61, v13
    v_cvt_pkrtz_f16_f32 v53, v58, v59
    v_sub_f32 v56, v40, v25
    v_sub_f32 v57, v41, v25
    v_cvt_pk_bf16_f32 v57, v56, v57
    v_lshlrev_b32 v56, 16, v57
    v_and_b32 v57, s61, v57
    v_mul_f32 v58, v56, v49
    v_mul_f32 v59, v57, v49
    v_fma_f32 v60, -v58, v45, v56
    v_fma_f32 v61, -v59, v45, v57
    v_fma_f32 v58, v60, v49, v58
    v_fma_f32 v59, v61, v49, v59
    v_cvt_pk_bf16_f32 v14, v58, v59
    v_lshlrev_b32 v58, 16, v14
    v_and_b32 v59, s61, v14
    v_cvt_pkrtz_f16_f32 v54, v58, v59
    v_sub_f32 v56, v42, v25
    v_sub_f32 v57, v43, v25
    v_cvt_pk_bf16_f32 v57, v56, v57
    v_lshlrev_b32 v56, 16, v57
    v_and_b32 v57, s61, v57
    v_mul_f32 v58, v56, v49
    v_mul_f32 v59, v57, v49
    v_fma_f32 v60, -v58, v45, v56
    v_fma_f32 v61, -v59, v45, v57
    v_fma_f32 v58, v60, v49, v58
    v_fma_f32 v59, v61, v49, v59
    v_cvt_pk_bf16_f32 v15, v58, v59
    v_lshlrev_b32 v58, 16, v15
    v_and_b32 v59, s61, v15
    v_cvt_pkrtz_f16_f32 v55, v58, v59
    buffer_store_dwordx4 v[12:15], v5, s[52:55], s40 offen offset:1024
    ds_write_b128 v50, v[52:55] offset:1056
    s_waitcnt lgkmcnt(0)
    s_barrier
    v_lshrrev_b32 v64, 2, v3
    v_mul_u32_u24 v62, 1056, v64
    v_and_b32 v64, 3, v3
    v_lshl_add_u32 v62, v64, 3, v62
    v_lshl_add_u32 v65, v2, 3, v4
    v_lshl_add_u32 v62, v65, 5, v62
    v_lshl_add_u32 v63, v65, 4, v3
    v_mul_u32_u24 v63, 4160, v63
    s_lshl_b32 s62, s2, 4
    s_add_u32 s62, s62, 64
    s_add_u32 s63, s62, 266240
    ds_read_b64_tr_b16 v[68:69], v62 offset:0
    ds_read_b64_tr_b16 v[70:71], v62 offset:4224
    ds_read_b64_tr_b16 v[72:73], v62 offset:128
    ds_read_b64_tr_b16 v[74:75], v62 offset:4352
    v_mov_b32 v76, 0
    v_mov_b32 v77, 0
    v_mov_b32 v78, 0
    v_mov_b32 v79, 0
    v_lshrrev_b32 v80, 2, v0
    v_mul_u32_u24 v80, 4160, v80
    v_and_b32 v64, 3, v0
    v_lshl_add_u32 v80, v64, 4, v80
    s_mul_i32 s64, s2, 8320
    v_cmp_gt_u32 vcc, 8, v0
    s_and_saveexec_b64 s[66:67], vcc
    s_cbranch_execz K1_NOZ
    buffer_store_dwordx4 v[76:79], v80, s[56:59], s64 offen
K1_NOZ:
    s_mov_b64 exec, s[66:67]
    s_waitcnt lgkmcnt(0)
    buffer_store_dwordx4 v[68:71], v63, s[56:59], s62 offen
    buffer_store_dwordx4 v[72:75], v63, s[56:59], s63 offen
    s_nop 1
    s_waitcnt vmcnt(0)
K1_END:
    s_endpgm
.globl k23_kernel
.p2align 8
.type k23_kernel,@function
k23_kernel:
    s_cmp_ge_u32 s2, 256
    s_cbranch_scc1 K23_END
    s_load_dwordx16 s[4:19], s[0:1], 0
    s_load_dwordx8 s[20:27], s[0:1], 64
    s_load_dwordx4 s[28:31], s[0:1], 96
    v_and_b32 v1, 63, v0
    v_lshrrev_b32 v2, 6, v0
    s_nop 0
    v_readfirstlane_b32 s32, v2
    s_waitcnt lgkmcnt(0)
    s_mov_b32 s33, s2
    s_cmp_ge_u32 s32, 4
    s_cbranch_scc1 K23_SIDE
    s_setprio 3
    s_add_u32 s36, s30, 0
    s_addc_u32 s37, s31, 0
    s_and_b32 s37, s37, 0xffff
    s_mov_b32 s38, 2097152
    s_mov_b32 s39, 0x00020000
    s_add_u32 s40, s30, 10485760
    s_addc_u32 s41, s31, 0
    s_and_b32 s41, s41, 0xffff
    s_mov_b32 s42, 7340032
    s_mov_b32 s43, 0x00020000
    s_lshr_b32 s44, s32, 1
    s_and_b32 s45, s32, 1
    s_cmp_eq_u32 s44, 0
    s_cselect_b32 s48, s20, s22
    s_cselect_b32 s49, s21, s23
    s_and_b32 s49, s49, 0xffff
    s_mov_b32 s50, 1835008
    s_mov_b32 s51, 0x00020000
    s_lshr_b32 s52, s33, 4
    s_and_b32 s53, s33, 15
    s_mul_i32 s54, s53, 224
    v_and_b32 v3, 15, v1
    v_lshrrev_b32 v4, 4, v1
    s_mul_i32 s56, s45, 114688
    s_add_u32 s56, s56, s54
    s_mul_i32 s57, s32, 7168
    v_lshrrev_b32 v12, 3, v1
    v_and_b32 v13, 7, v1
    v_xor_b32 v13, v13, v12
    v_lshlrev_b32 v13, 4, v13
    v_lshl_add_u32 v16, v12, 10, v13
    s_lshl_b32 s60, s52, 7
    s_lshl_b32 s46, s32, 5
    s_add_u32 s60, s60, s46
    s_lshl_b32 s61, s60, 10
    s_lshl_b32 s62, s32, 12
    s_add_u32 s62, s62, 28672
    s_add_u32 s59, s61, 0
    s_add_u32 m0, s62, 0
    s_nop 0
    buffer_load_dwordx4 v16, s[36:39], s59 offen lds
    s_add_u32 s59, s61, 8192
    s_add_u32 m0, s62, 1024
    s_nop 0
    buffer_load_dwordx4 v16, s[36:39], s59 offen lds
    s_add_u32 s59, s61, 16384
    s_add_u32 m0, s62, 2048
    s_nop 0
    buffer_load_dwordx4 v16, s[36:39], s59 offen lds
    s_add_u32 s59, s61, 24576
    s_add_u32 m0, s62, 3072
    s_nop 0
    buffer_load_dwordx4 v16, s[36:39], s59 offen lds
    s_mov_b32 s55, 4682
    v_add_u32 v12, 0, v1
    v_mul_lo_u32 v13, v12, s55
    v_lshrrev_b32 v13, 16, v13
    v_mul_u32_u24 v14, 14, v13
    v_sub_u32 v12, v12, v14
    v_lshrrev_b32 v14, 1, v12
    v_bfe_u32 v15, v13, 3, 1
    v_mul_u32_u24 v15, 3, v15
    v_add_u32 v14, v14, v15
    v_subrev_u32 v15, 7, v14
    v_cmp_le_u32 vcc, 7, v14
    s_nop 1
    v_cndmask_b32 v14, v14, v15, vcc
    v_and_b32 v12, 1, v12
    v_lshlrev_b32 v12, 4, v12
    v_lshl_add_u32 v12, v14, 5, v12
    v_mul_u32_u24 v13, 3584, v13
    v_add_u32 v5, v12, v13
    s_add_u32 s58, s56, 0
    s_add_u32 m0, s57, 0
    s_nop 0
    buffer_load_dwordx4 v5, s[48:51], s58 offen lds
    v_add_u32 v12, 64, v1
    v_mul_lo_u32 v13, v12, s55
    v_lshrrev_b32 v13, 16, v13
    v_mul_u32_u24 v14, 14, v13
    v_sub_u32 v12, v12, v14
    v_lshrrev_b32 v14, 1, v12
    v_bfe_u32 v15, v13, 3, 1
    v_mul_u32_u24 v15, 3, v15
    v_add_u32 v14, v14, v15
    v_subrev_u32 v15, 7, v14
    v_cmp_le_u32 vcc, 7, v14
    s_nop 1
    v_cndmask_b32 v14, v14, v15, vcc
    v_and_b32 v12, 1, v12
    v_lshlrev_b32 v12, 4, v12
    v_lshl_add_u32 v12, v14, 5, v12
    v_mul_u32_u24 v13, 3584, v13
    v_add_u32 v6, v12, v13
    s_add_u32 m0, s57, 1024
    s_nop 0
    buffer_load_dwordx4 v6, s[48:51], s58 offen lds
    v_add_u32 v12, 128, v1
    v_mul_lo_u32 v13, v12, s55
    v_lshrrev_b32 v13, 16, v13
    v_mul_u32_u24 v14, 14, v13
    v_sub_u32 v12, v12, v14
    v_lshrrev_b32 v14, 1, v12
    v_bfe_u32 v15, v13, 3, 1
    v_mul_u32_u24 v15, 3, v15
    v_add_u32 v14, v14, v15
    v_subrev_u32 v15, 7, v14
    v_cmp_le_u32 vcc, 7, v14
    s_nop 1
    v_cndmask_b32 v14, v14, v15, vcc
    v_and_b32 v12, 1, v12
    v_lshlrev_b32 v12, 4, v12
    v_lshl_add_u32 v12, v14, 5, v12
    v_mul_u32_u24 v13, 3584, v13
    v_add_u32 v7, v12, v13
    s_add_u32 m0, s57, 2048
    s_nop 0
    buffer_load_dwordx4 v7, s[48:51], s58 offen lds
    v_add_u32 v12, 192, v1
    v_mul_lo_u32 v13, v12, s55
    v_lshrrev_b32 v13, 16, v13
    v_mul_u32_u24 v14, 14, v13
    v_sub_u32 v12, v12, v14
    v_lshrrev_b32 v14, 1, v12
    v_bfe_u32 v15, v13, 3, 1
    v_mul_u32_u24 v15, 3, v15
    v_add_u32 v14, v14, v15
    v_subrev_u32 v15, 7, v14
    v_cmp_le_u32 vcc, 7, v14
    s_nop 1
    v_cndmask_b32 v14, v14, v15, vcc
    v_and_b32 v12, 1, v12
    v_lshlrev_b32 v12, 4, v12
    v_lshl_add_u32 v12, v14, 5, v12
    v_mul_u32_u24 v13, 3584, v13
    v_add_u32 v8, v12, v13
    s_add_u32 m0, s57, 3072
    s_nop 0
    buffer_load_dwordx4 v8, s[48:51], s58 offen lds
    v_add_u32 v12, 256, v1
    v_mul_lo_u32 v13, v12, s55
    v_lshrrev_b32 v13, 16, v13
    v_mul_u32_u24 v14, 14, v13
    v_sub_u32 v12, v12, v14
    v_lshrrev_b32 v14, 1, v12
    v_bfe_u32 v15, v13, 3, 1
    v_mul_u32_u24 v15, 3, v15
    v_add_u32 v14, v14, v15
    v_subrev_u32 v15, 7, v14
    v_cmp_le_u32 vcc, 7, v14
    s_nop 1
    v_cndmask_b32 v14, v14, v15, vcc
    v_and_b32 v12, 1, v12
    v_lshlrev_b32 v12, 4, v12
    v_lshl_add_u32 v12, v14, 5, v12
    v_mul_u32_u24 v13, 3584, v13
    v_add_u32 v9, v12, v13
    s_add_u32 m0, s57, 4096
    s_nop 0
    buffer_load_dwordx4 v9, s[48:51], s58 offen lds
    v_add_u32 v12, 320, v1
    v_mul_lo_u32 v13, v12, s55
    v_lshrrev_b32 v13, 16, v13
    v_mul_u32_u24 v14, 14, v13
    v_sub_u32 v12, v12, v14
    v_lshrrev_b32 v14, 1, v12
    v_bfe_u32 v15, v13, 3, 1
    v_mul_u32_u24 v15, 3, v15
    v_add_u32 v14, v14, v15
    v_subrev_u32 v15, 7, v14
    v_cmp_le_u32 vcc, 7, v14
    s_nop 1
    v_cndmask_b32 v14, v14, v15, vcc
    v_and_b32 v12, 1, v12
    v_lshlrev_b32 v12, 4, v12
    v_lshl_add_u32 v12, v14, 5, v12
    v_mul_u32_u24 v13, 3584, v13
    v_add_u32 v10, v12, v13
    s_add_u32 m0, s57, 5120
    s_nop 0
    buffer_load_dwordx4 v10, s[48:51], s58 offen lds
    v_add_u32 v12, 384, v1
    v_mul_lo_u32 v13, v12, s55
    v_lshrrev_b32 v13, 16, v13
    v_mul_u32_u24 v14, 14, v13
    v_sub_u32 v12, v12, v14
    v_lshrrev_b32 v14, 1, v12
    v_bfe_u32 v15, v13, 3, 1
    v_mul_u32_u24 v15, 3, v15
    v_add_u32 v14, v14, v15
    v_subrev_u32 v15, 7, v14
    v_cmp_le_u32 vcc, 7, v14
    s_nop 1
    v_cndmask_b32 v14, v14, v15, vcc
    v_and_b32 v12, 1, v12
    v_lshlrev_b32 v12, 4, v12
    v_lshl_add_u32 v12, v14, 5, v12
    v_mul_u32_u24 v13, 3584, v13
    v_add_u32 v11, v12, v13
    s_add_u32 m0, s57, 6144
    s_nop 0
    buffer_load_dwordx4 v11, s[48:51], s58 offen lds
    s_add_u32 s58, s56, 229376
    s_add_u32 m0, s57, 45056
    s_nop 0
    buffer_load_dwordx4 v5, s[48:51], s58 offen lds
    s_add_u32 s59, s61, 128
    s_add_u32 m0, s62, 45056
    s_nop 0
    buffer_load_dwordx4 v16, s[36:39], s59 offen lds
    s_add_u32 m0, s57, 46080
    s_nop 0
    buffer_load_dwordx4 v6, s[48:51], s58 offen lds
    s_add_u32 s59, s61, 8320
    s_add_u32 m0, s62, 46080
    s_nop 0
    buffer_load_dwordx4 v16, s[36:39], s59 offen lds
    s_add_u32 m0, s57, 47104
    s_nop 0
    buffer_load_dwordx4 v7, s[48:51], s58 offen lds
    s_add_u32 s59, s61, 16512
    s_add_u32 m0, s62, 47104
    s_nop 0
    buffer_load_dwordx4 v16, s[36:39], s59 offen lds
    s_add_u32 m0, s57, 48128
    s_nop 0
    buffer_load_dwordx4 v8, s[48:51], s58 offen lds
    s_add_u32 s59, s61, 24704
    s_add_u32 m0, s62, 48128
    s_nop 0
    buffer_load_dwordx4 v16, s[36:39], s59 offen lds
    s_add_u32 m0, s57, 49152
    s_nop 0
    buffer_load_dwordx4 v9, s[48:51], s58 offen lds
    s_add_u32 m0, s57, 50176
    s_nop 0
    buffer_load_dwordx4 v10, s[48:51], s58 offen lds
    s_add_u32 m0, s57, 51200
    s_nop 0
    buffer_load_dwordx4 v11, s[48:51], s58 offen lds
    v_and_b32 v13, 7, v3
    v_xor_b32 v13, v13, v4
    v_lshlrev_b32 v12, 7, v3
    v_add_u32 v12, s62, v12
    v_lshl_add_u32 v17, v13, 4, v12
    v_xor_b32 v13, 4, v13
    v_lshl_add_u32 v18, v13, 4, v12
    v_add_u32 v19, 65536, v17
    v_add_u32 v20, 65536, v18
    v_add_u32 v12, s60, v3
    v_mul_u32_u24 v13, 3584, v12
    v_lshl_add_u32 v13, v4, 3, v13
    v_add_u32 v21, s54, v13
    v_add_u32 v22, 57344, v21
    v_lshrrev_b32 v30, 2, v3
    v_lshl_add_u32 v12, v4, 3, v30
    v_mul_u32_u24 v12, 224, v12
    v_and_b32 v13, 3, v3
    v_lshl_add_u32 v12, v13, 3, v12
    v_and_b32 v13, 1, v4
    v_cmp_eq_u32 vcc, 1, v13
    v_mov_b32 v13, 0
    v_mov_b32 v14, 128
    v_cndmask_b32 v13, v13, v14, vcc
    v_add_u32 v23, v12, v13
    v_mov_b32 v13, 32
    v_mov_b32 v14, 160
    v_cndmask_b32 v13, v13, v14, vcc
    v_add_u32 v24, v12, v13
    v_mov_b32 v13, 64
    v_mov_b32 v14, 192
    v_cndmask_b32 v13, v13, v14, vcc
    v_add_u32 v25, v12, v13
    v_mov_b32 v13, 96
    v_mov_b32 v14, 0
    v_cndmask_b32 v13, v13, v14, vcc
    v_add_u32 v26, v12, v13
    v_mov_b32 v13, 128
    v_mov_b32 v14, 32
    v_cndmask_b32 v13, v13, v14, vcc
    v_add_u32 v27, v12, v13
    v_mov_b32 v13, 160
    v_mov_b32 v14, 64
    v_cndmask_b32 v13, v13, v14, vcc
    v_add_u32 v28, v12, v13
    v_mov_b32 v13, 192
    v_mov_b32 v14, 96
    v_cndmask_b32 v13, v13, v14, vcc
    v_add_u32 v29, v12, v13
    v_add_u32 v31, 65536, v23
    v_add_u32 v32, 65536, v24
    v_add_u32 v33, 65536, v25
    v_add_u32 v34, 65536, v26
    v_add_u32 v35, 65536, v27
    v_add_u32 v36, 65536, v28
    v_add_u32 v37, 65536, v29
    v_mov_b32 v152, 162464
    v_mov_b32 v153, 1
    v_mov_b32 v154, 0
    ds_write_b32 v152, v154
    s_waitcnt lgkmcnt(0)
    s_waitcnt vmcnt(11)
    s_barrier
    ds_read_b128 v[180:183], v17 offset:0
    ds_read_b128 v[184:187], v17 offset:2048
    ds_read_b128 v[188:191], v18 offset:0
    ds_read_b128 v[192:195], v18 offset:2048
    ds_read_b64_tr_b16 v[156:157], v23 offset:0
    ds_read_b64_tr_b16 v[158:159], v23 offset:896
    ds_read_b64_tr_b16 v[160:161], v23 offset:14336
    ds_read_b64_tr_b16 v[162:163], v23 offset:15232
    ds_read_b64_tr_b16 v[164:165], v24 offset:0
    ds_read_b64_tr_b16 v[166:167], v24 offset:896
    ds_read_b64_tr_b16 v[168:169], v24 offset:14336
    ds_read_b64_tr_b16 v[170:171], v24 offset:15232
    ds_read_b64_tr_b16 v[172:173], v25 offset:0
    ds_read_b64_tr_b16 v[174:175], v25 offset:896
    ds_read_b64_tr_b16 v[176:177], v25 offset:14336
    ds_read_b64_tr_b16 v[178:179], v25 offset:15232
    s_waitcnt lgkmcnt(10)
    v_mfma_f32_16x16x32_bf16 v[40:43], v[156:159], v[180:183], 0
    v_mfma_f32_16x16x32_bf16 v[44:47], v[156:159], v[184:187], 0
    s_add_u32 s58, s56, 458752
    s_add_u32 m0, s57, 90112
    s_nop 0
    buffer_load_dwordx4 v5, s[48:51], s58 offen lds
    ds_read_b64_tr_b16 v[156:157], v26 offset:0
    ds_read_b64_tr_b16 v[158:159], v26 offset:896
    s_waitcnt lgkmcnt(10)
    v_mfma_f32_16x16x32_bf16 v[96:99], v[160:163], v[180:183], 0
    v_mfma_f32_16x16x32_bf16 v[100:103], v[160:163], v[184:187], 0
    ds_read_b64_tr_b16 v[160:161], v26 offset:14336
    ds_read_b64_tr_b16 v[162:163], v26 offset:15232
    s_waitcnt lgkmcnt(10)
    v_mfma_f32_16x16x32_bf16 v[48:51], v[164:167], v[180:183], 0
    v_mfma_f32_16x16x32_bf16 v[52:55], v[164:167], v[184:187], 0
    s_add_u32 s59, s61, 256
    s_add_u32 m0, s62, 90112
    s_nop 0
    buffer_load_dwordx4 v16, s[36:39], s59 offen lds
    ds_read_b64_tr_b16 v[164:165], v27 offset:0
    ds_read_b64_tr_b16 v[166:167], v27 offset:896
    s_waitcnt lgkmcnt(10)
    v_mfma_f32_16x16x32_bf16 v[104:107], v[168:171], v[180:183], 0
    v_mfma_f32_16x16x32_bf16 v[108:111], v[168:171], v[184:187], 0
    ds_read_b64_tr_b16 v[168:169], v27 offset:14336
    ds_read_b64_tr_b16 v[170:171], v27 offset:15232
    s_waitcnt lgkmcnt(10)
    v_mfma_f32_16x16x32_bf16 v[56:59], v[172:175], v[180:183], 0
    v_mfma_f32_16x16x32_bf16 v[60:63], v[172:175], v[184:187], 0
    s_add_u32 m0, s57, 91136
    s_nop 0
    buffer_load_dwordx4 v6, s[48:51], s58 offen lds
    ds_read_b64_tr_b16 v[172:173], v28 offset:0
    ds_read_b64_tr_b16 v[174:175], v28 offset:896
    s_waitcnt lgkmcnt(10)
    v_mfma_f32_16x16x32_bf16 v[112:115], v[176:179], v[180:183], 0
    v_mfma_f32_16x16x32_bf16 v[116:119], v[176:179], v[184:187], 0
    ds_read_b64_tr_b16 v[176:177], v28 offset:14336
    ds_read_b64_tr_b16 v[178:179], v28 offset:15232
    s_waitcnt lgkmcnt(10)
    v_mfma_f32_16x16x32_bf16 v[64:67], v[156:159], v[180:183], 0
    v_mfma_f32_16x16x32_bf16 v[68:71], v[156:159], v[184:187], 0
    s_add_u32 s59, s61, 8448
    s_add_u32 m0, s62, 91136
    s_nop 0
    buffer_load_dwordx4 v16, s[36:39], s59 offen lds
    ds_read_b64_tr_b16 v[156:157], v29 offset:0
    ds_read_b64_tr_b16 v[158:159], v29 offset:896
    s_waitcnt lgkmcnt(10)
    v_mfma_f32_16x16x32_bf16 v[120:123], v[160:163], v[180:183], 0
    v_mfma_f32_16x16x32_bf16 v[124:127], v[160:163], v[184:187], 0
    ds_read_b64_tr_b16 v[160:161], v29 offset:14336
    ds_read_b64_tr_b16 v[162:163], v29 offset:15232
    s_waitcnt lgkmcnt(10)
    v_mfma_f32_16x16x32_bf16 v[72:75], v[164:167], v[180:183], 0
    v_mfma_f32_16x16x32_bf16 v[76:79], v[164:167], v[184:187], 0
    s_add_u32 m0, s57, 92160
    s_nop 0
    buffer_load_dwordx4 v7, s[48:51], s58 offen lds
    ds_read_b64_tr_b16 v[164:165], v23 offset:7168
    ds_read_b64_tr_b16 v[166:167], v23 offset:8064
    s_waitcnt lgkmcnt(10)
    v_mfma_f32_16x16x32_bf16 v[128:131], v[168:171], v[180:183], 0
    v_mfma_f32_16x16x32_bf16 v[132:135], v[168:171], v[184:187], 0
    ds_read_b64_tr_b16 v[168:169], v23 offset:21504
    ds_read_b64_tr_b16 v[170:171], v23 offset:22400
    s_waitcnt lgkmcnt(10)
    v_mfma_f32_16x16x32_bf16 v[80:83], v[172:175], v[180:183], 0
    v_mfma_f32_16x16x32_bf16 v[84:87], v[172:175], v[184:187], 0
    s_add_u32 s59, s61, 16640
    s_add_u32 m0, s62, 92160
    s_nop 0
    buffer_load_dwordx4 v16, s[36:39], s59 offen lds
    ds_read_b64_tr_b16 v[172:173], v24 offset:7168
    ds_read_b64_tr_b16 v[174:175], v24 offset:8064
    s_waitcnt lgkmcnt(10)
    v_mfma_f32_16x16x32_bf16 v[136:139], v[176:179], v[180:183], 0
    v_mfma_f32_16x16x32_bf16 v[140:143], v[176:179], v[184:187], 0
    ds_read_b64_tr_b16 v[176:177], v24 offset:21504
    ds_read_b64_tr_b16 v[178:179], v24 offset:22400
    s_waitcnt lgkmcnt(10)
    v_mfma_f32_16x16x32_bf16 v[88:91], v[156:159], v[180:183], 0
    v_mfma_f32_16x16x32_bf16 v[92:95], v[156:159], v[184:187], 0
    s_add_u32 m0, s57, 93184
    s_nop 0
    buffer_load_dwordx4 v8, s[48:51], s58 offen lds
    ds_read_b64_tr_b16 v[156:157], v25 offset:7168
    ds_read_b64_tr_b16 v[158:159], v25 offset:8064
    s_waitcnt lgkmcnt(10)
    v_mfma_f32_16x16x32_bf16 v[144:147], v[160:163], v[180:183], 0
    v_mfma_f32_16x16x32_bf16 v[148:151], v[160:163], v[184:187], 0
    ds_read_b64_tr_b16 v[160:161], v25 offset:21504
    ds_read_b64_tr_b16 v[162:163], v25 offset:22400
    s_waitcnt lgkmcnt(10)
    v_mfma_f32_16x16x32_bf16 v[40:43], v[164:167], v[188:191], v[40:43]
    v_mfma_f32_16x16x32_bf16 v[44:47], v[164:167], v[192:195], v[44:47]
    s_add_u32 s59, s61, 24832
    s_add_u32 m0, s62, 93184
    s_nop 0
    buffer_load_dwordx4 v16, s[36:39], s59 offen lds
    ds_read_b64_tr_b16 v[164:165], v26 offset:7168
    ds_read_b64_tr_b16 v[166:167], v26 offset:8064
    s_waitcnt lgkmcnt(10)
    v_mfma_f32_16x16x32_bf16 v[96:99], v[168:171], v[188:191], v[96:99]
    v_mfma_f32_16x16x32_bf16 v[100:103], v[168:171], v[192:195], v[100:103]
    ds_read_b64_tr_b16 v[168:169], v26 offset:21504
    ds_read_b64_tr_b16 v[170:171], v26 offset:22400
    s_waitcnt lgkmcnt(10)
    v_mfma_f32_16x16x32_bf16 v[48:51], v[172:175], v[188:191], v[48:51]
    v_mfma_f32_16x16x32_bf16 v[52:55], v[172:175], v[192:195], v[52:55]
    s_add_u32 m0, s57, 94208
    s_nop 0
    buffer_load_dwordx4 v9, s[48:51], s58 offen lds
    ds_read_b64_tr_b16 v[172:173], v27 offset:7168
    ds_read_b64_tr_b16 v[174:175], v27 offset:8064
    s_waitcnt lgkmcnt(10)
    v_mfma_f32_16x16x32_bf16 v[104:107], v[176:179], v[188:191], v[104:107]
    v_mfma_f32_16x16x32_bf16 v[108:111], v[176:179], v[192:195], v[108:111]
    ds_read_b64_tr_b16 v[176:177], v27 offset:21504
    ds_read_b64_tr_b16 v[178:179], v27 offset:22400
    s_waitcnt lgkmcnt(10)
    v_mfma_f32_16x16x32_bf16 v[56:59], v[156:159], v[188:191], v[56:59]
    v_mfma_f32_16x16x32_bf16 v[60:63], v[156:159], v[192:195], v[60:63]
    s_add_u32 m0, s57, 95232
    s_nop 0
    buffer_load_dwordx4 v10, s[48:51], s58 offen lds
    ds_read_b64_tr_b16 v[156:157], v28 offset:7168
    ds_read_b64_tr_b16 v[158:159], v28 offset:8064
    s_waitcnt lgkmcnt(10)
    v_mfma_f32_16x16x32_bf16 v[112:115], v[160:163], v[188:191], v[112:115]
    v_mfma_f32_16x16x32_bf16 v[116:119], v[160:163], v[192:195], v[116:119]
    ds_read_b64_tr_b16 v[160:161], v28 offset:21504
    ds_read_b64_tr_b16 v[162:163], v28 offset:22400
    s_waitcnt lgkmcnt(10)
    v_mfma_f32_16x16x32_bf16 v[64:67], v[164:167], v[188:191], v[64:67]
    v_mfma_f32_16x16x32_bf16 v[68:71], v[164:167], v[192:195], v[68:71]
    s_add_u32 m0, s57, 96256
    s_nop 0
    buffer_load_dwordx4 v11, s[48:51], s58 offen lds
    ds_read_b64_tr_b16 v[164:165], v29 offset:7168
    ds_read_b64_tr_b16 v[166:167], v29 offset:8064
    s_waitcnt lgkmcnt(10)
    v_mfma_f32_16x16x32_bf16 v[120:123], v[168:171], v[188:191], v[120:123]
    v_mfma_f32_16x16x32_bf16 v[124:127], v[168:171], v[192:195], v[124:127]
    ds_read_b64_tr_b16 v[168:169], v29 offset:21504
    ds_read_b64_tr_b16 v[170:171], v29 offset:22400
    s_waitcnt lgkmcnt(10)
    v_mfma_f32_16x16x32_bf16 v[72:75], v[172:175], v[188:191], v[72:75]
    v_mfma_f32_16x16x32_bf16 v[76:79], v[172:175], v[192:195], v[76:79]
    s_waitcnt lgkmcnt(8)
    v_mfma_f32_16x16x32_bf16 v[128:131], v[176:179], v[188:191], v[128:131]
    v_mfma_f32_16x16x32_bf16 v[132:135], v[176:179], v[192:195], v[132:135]
    s_waitcnt lgkmcnt(6)
    v_mfma_f32_16x16x32_bf16 v[80:83], v[156:159], v[188:191], v[80:83]
    v_mfma_f32_16x16x32_bf16 v[84:87], v[156:159], v[192:195], v[84:87]
    s_waitcnt lgkmcnt(4)
    v_mfma_f32_16x16x32_bf16 v[136:139], v[160:163], v[188:191], v[136:139]
    v_mfma_f32_16x16x32_bf16 v[140:143], v[160:163], v[192:195], v[140:143]
    s_waitcnt lgkmcnt(2)
    v_mfma_f32_16x16x32_bf16 v[88:91], v[164:167], v[188:191], v[88:91]
    v_mfma_f32_16x16x32_bf16 v[92:95], v[164:167], v[192:195], v[92:95]
    s_waitcnt lgkmcnt(0)
    v_mfma_f32_16x16x32_bf16 v[144:147], v[168:171], v[188:191], v[144:147]
    v_mfma_f32_16x16x32_bf16 v[148:151], v[168:171], v[192:195], v[148:151]
    s_waitcnt vmcnt(11)
    s_mov_b64 exec, 1
    ds_add_u32 v152, v153
    s_mov_b64 exec, -1
    s_nop 3
GSPIN_1:
    ds_read_b32 v154, v152
    s_waitcnt lgkmcnt(0)
    v_readfirstlane_b32 s63, v154
    s_cmp_lt_u32 s63, 4
    s_cbranch_scc1 GSPIN_1
    ds_read_b128 v[180:183], v17 offset:45056
    ds_read_b128 v[184:187], v17 offset:47104
    ds_read_b128 v[188:191], v18 offset:45056
    ds_read_b128 v[192:195], v18 offset:47104
    ds_read_b64_tr_b16 v[156:157], v23 offset:45056
    ds_read_b64_tr_b16 v[158:159], v23 offset:45952
    ds_read_b64_tr_b16 v[160:161], v23 offset:59392
    ds_read_b64_tr_b16 v[162:163], v23 offset:60288
    ds_read_b64_tr_b16 v[164:165], v24 offset:45056
    ds_read_b64_tr_b16 v[166:167], v24 offset:45952
    ds_read_b64_tr_b16 v[168:169], v24 offset:59392
    ds_read_b64_tr_b16 v[170:171], v24 offset:60288
    ds_read_b64_tr_b16 v[172:173], v25 offset:45056
    ds_read_b64_tr_b16 v[174:175], v25 offset:45952
    ds_read_b64_tr_b16 v[176:177], v25 offset:59392
    ds_read_b64_tr_b16 v[178:179], v25 offset:60288
    s_waitcnt lgkmcnt(10)
    v_mfma_f32_16x16x32_bf16 v[40:43], v[156:159], v[180:183], v[40:43]
    v_mfma_f32_16x16x32_bf16 v[44:47], v[156:159], v[184:187], v[44:47]
    s_add_u32 s58, s56, 688128
    s_add_u32 m0, s57, 0
    s_nop 0
    buffer_load_dwordx4 v5, s[48:51], s58 offen lds
    ds_read_b64_tr_b16 v[156:157], v26 offset:45056
    ds_read_b64_tr_b16 v[158:159], v26 offset:45952
    s_waitcnt lgkmcnt(10)
    v_mfma_f32_16x16x32_bf16 v[96:99], v[160:163], v[180:183], v[96:99]
    v_mfma_f32_16x16x32_bf16 v[100:103], v[160:163], v[184:187], v[100:103]
    ds_read_b64_tr_b16 v[160:161], v26 offset:59392
    ds_read_b64_tr_b16 v[162:163], v26 offset:60288
    s_waitcnt lgkmcnt(10)
    v_mfma_f32_16x16x32_bf16 v[48:51], v[164:167], v[180:183], v[48:51]
    v_mfma_f32_16x16x32_bf16 v[52:55], v[164:167], v[184:187], v[52:55]
    s_add_u32 s59, s61, 384
    s_add_u32 m0, s62, 0
    s_nop 0
    buffer_load_dwordx4 v16, s[36:39], s59 offen lds
    ds_read_b64_tr_b16 v[164:165], v27 offset:45056
    ds_read_b64_tr_b16 v[166:167], v27 offset:45952
    s_waitcnt lgkmcnt(10)
    v_mfma_f32_16x16x32_bf16 v[104:107], v[168:171], v[180:183], v[104:107]
    v_mfma_f32_16x16x32_bf16 v[108:111], v[168:171], v[184:187], v[108:111]
    ds_read_b64_tr_b16 v[168:169], v27 offset:59392
    ds_read_b64_tr_b16 v[170:171], v27 offset:60288
    s_waitcnt lgkmcnt(10)
    v_mfma_f32_16x16x32_bf16 v[56:59], v[172:175], v[180:183], v[56:59]
    v_mfma_f32_16x16x32_bf16 v[60:63], v[172:175], v[184:187], v[60:63]
    s_add_u32 m0, s57, 1024
    s_nop 0
    buffer_load_dwordx4 v6, s[48:51], s58 offen lds
    ds_read_b64_tr_b16 v[172:173], v28 offset:45056
    ds_read_b64_tr_b16 v[174:175], v28 offset:45952
    s_waitcnt lgkmcnt(10)
    v_mfma_f32_16x16x32_bf16 v[112:115], v[176:179], v[180:183], v[112:115]
    v_mfma_f32_16x16x32_bf16 v[116:119], v[176:179], v[184:187], v[116:119]
    ds_read_b64_tr_b16 v[176:177], v28 offset:59392
    ds_read_b64_tr_b16 v[178:179], v28 offset:60288
    s_waitcnt lgkmcnt(10)
    v_mfma_f32_16x16x32_bf16 v[64:67], v[156:159], v[180:183], v[64:67]
    v_mfma_f32_16x16x32_bf16 v[68:71], v[156:159], v[184:187], v[68:71]
    s_add_u32 s59, s61, 8576
    s_add_u32 m0, s62, 1024
    s_nop 0
    buffer_load_dwordx4 v16, s[36:39], s59 offen lds
    ds_read_b64_tr_b16 v[156:157], v29 offset:45056
    ds_read_b64_tr_b16 v[158:159], v29 offset:45952
    s_waitcnt lgkmcnt(10)
    v_mfma_f32_16x16x32_bf16 v[120:123], v[160:163], v[180:183], v[120:123]
    v_mfma_f32_16x16x32_bf16 v[124:127], v[160:163], v[184:187], v[124:127]
    ds_read_b64_tr_b16 v[160:161], v29 offset:59392
    ds_read_b64_tr_b16 v[162:163], v29 offset:60288
    s_waitcnt lgkmcnt(10)
    v_mfma_f32_16x16x32_bf16 v[72:75], v[164:167], v[180:183], v[72:75]
    v_mfma_f32_16x16x32_bf16 v[76:79], v[164:167], v[184:187], v[76:79]
    s_add_u32 m0, s57, 2048
    s_nop 0
    buffer_load_dwordx4 v7, s[48:51], s58 offen lds
    ds_read_b64_tr_b16 v[164:165], v23 offset:52224
    ds_read_b64_tr_b16 v[166:167], v23 offset:53120
    s_waitcnt lgkmcnt(10)
    v_mfma_f32_16x16x32_bf16 v[128:131], v[168:171], v[180:183], v[128:131]
    v_mfma_f32_16x16x32_bf16 v[132:135], v[168:171], v[184:187], v[132:135]
    ds_read_b64_tr_b16 v[168:169], v31 offset:1024
    ds_read_b64_tr_b16 v[170:171], v31 offset:1920
    s_waitcnt lgkmcnt(10)
    v_mfma_f32_16x16x32_bf16 v[80:83], v[172:175], v[180:183], v[80:83]
    v_mfma_f32_16x16x32_bf16 v[84:87], v[172:175], v[184:187], v[84:87]
    s_add_u32 s59, s61, 16768
    s_add_u32 m0, s62, 2048
    s_nop 0
    buffer_load_dwordx4 v16, s[36:39], s59 offen lds
    ds_read_b64_tr_b16 v[172:173], v24 offset:52224
    ds_read_b64_tr_b16 v[174:175], v24 offset:53120
    s_waitcnt lgkmcnt(10)
    v_mfma_f32_16x16x32_bf16 v[136:139], v[176:179], v[180:183], v[136:139]
    v_mfma_f32_16x16x32_bf16 v[140:143], v[176:179], v[184:187], v[140:143]
    ds_read_b64_tr_b16 v[176:177], v32 offset:1024
    ds_read_b64_tr_b16 v[178:179], v32 offset:1920
    s_waitcnt lgkmcnt(10)
    v_mfma_f32_16x16x32_bf16 v[88:91], v[156:159], v[180:183], v[88:91]
    v_mfma_f32_16x16x32_bf16 v[92:95], v[156:159], v[184:187], v[92:95]
    s_add_u32 m0, s57, 3072
    s_nop 0
    buffer_load_dwordx4 v8, s[48:51], s58 offen lds
    ds_read_b64_tr_b16 v[156:157], v25 offset:52224
    ds_read_b64_tr_b16 v[158:159], v25 offset:53120
    s_waitcnt lgkmcnt(10)
    v_mfma_f32_16x16x32_bf16 v[144:147], v[160:163], v[180:183], v[144:147]
    v_mfma_f32_16x16x32_bf16 v[148:151], v[160:163], v[184:187], v[148:151]
    ds_read_b64_tr_b16 v[160:161], v33 offset:1024
    ds_read_b64_tr_b16 v[162:163], v33 offset:1920
    s_waitcnt lgkmcnt(10)
    v_mfma_f32_16x16x32_bf16 v[40:43], v[164:167], v[188:191], v[40:43]
    v_mfma_f32_16x16x32_bf16 v[44:47], v[164:167], v[192:195], v[44:47]
    s_add_u32 s59, s61, 24960
    s_add_u32 m0, s62, 3072
    s_nop 0
    buffer_load_dwordx4 v16, s[36:39], s59 offen lds
    ds_read_b64_tr_b16 v[164:165], v26 offset:52224
    ds_read_b64_tr_b16 v[166:167], v26 offset:53120
    s_waitcnt lgkmcnt(10)
    v_mfma_f32_16x16x32_bf16 v[96:99], v[168:171], v[188:191], v[96:99]
    v_mfma_f32_16x16x32_bf16 v[100:103], v[168:171], v[192:195], v[100:103]
    ds_read_b64_tr_b16 v[168:169], v34 offset:1024
    ds_read_b64_tr_b16 v[170:171], v34 offset:1920
    s_waitcnt lgkmcnt(10)
    v_mfma_f32_16x16x32_bf16 v[48:51], v[172:175], v[188:191], v[48:51]
    v_mfma_f32_16x16x32_bf16 v[52:55], v[172:175], v[192:195], v[52:55]
    s_add_u32 m0, s57, 4096
    s_nop 0
    buffer_load_dwordx4 v9, s[48:51], s58 offen lds
    ds_read_b64_tr_b16 v[172:173], v27 offset:52224
    ds_read_b64_tr_b16 v[174:175], v27 offset:53120
    s_waitcnt lgkmcnt(10)
    v_mfma_f32_16x16x32_bf16 v[104:107], v[176:179], v[188:191], v[104:107]
    v_mfma_f32_16x16x32_bf16 v[108:111], v[176:179], v[192:195], v[108:111]
    ds_read_b64_tr_b16 v[176:177], v35 offset:1024
    ds_read_b64_tr_b16 v[178:179], v35 offset:1920
    s_waitcnt lgkmcnt(10)
    v_mfma_f32_16x16x32_bf16 v[56:59], v[156:159], v[188:191], v[56:59]
    v_mfma_f32_16x16x32_bf16 v[60:63], v[156:159], v[192:195], v[60:63]
    s_add_u32 m0, s57, 5120
    s_nop 0
    buffer_load_dwordx4 v10, s[48:51], s58 offen lds
    ds_read_b64_tr_b16 v[156:157], v28 offset:52224
    ds_read_b64_tr_b16 v[158:159], v28 offset:53120
    s_waitcnt lgkmcnt(10)
    v_mfma_f32_16x16x32_bf16 v[112:115], v[160:163], v[188:191], v[112:115]
    v_mfma_f32_16x16x32_bf16 v[116:119], v[160:163], v[192:195], v[116:119]
    ds_read_b64_tr_b16 v[160:161], v36 offset:1024
    ds_read_b64_tr_b16 v[162:163], v36 offset:1920
    s_waitcnt lgkmcnt(10)
    v_mfma_f32_16x16x32_bf16 v[64:67], v[164:167], v[188:191], v[64:67]
    v_mfma_f32_16x16x32_bf16 v[68:71], v[164:167], v[192:195], v[68:71]
    s_add_u32 m0, s57, 6144
    s_nop 0
    buffer_load_dwordx4 v11, s[48:51], s58 offen lds
    ds_read_b64_tr_b16 v[164:165], v29 offset:52224
    ds_read_b64_tr_b16 v[166:167], v29 offset:53120
    s_waitcnt lgkmcnt(10)
    v_mfma_f32_16x16x32_bf16 v[120:123], v[168:171], v[188:191], v[120:123]
    v_mfma_f32_16x16x32_bf16 v[124:127], v[168:171], v[192:195], v[124:127]
    ds_read_b64_tr_b16 v[168:169], v37 offset:1024
    ds_read_b64_tr_b16 v[170:171], v37 offset:1920
    s_waitcnt lgkmcnt(10)
    v_mfma_f32_16x16x32_bf16 v[72:75], v[172:175], v[188:191], v[72:75]
    v_mfma_f32_16x16x32_bf16 v[76:79], v[172:175], v[192:195], v[76:79]
    s_waitcnt lgkmcnt(8)
    v_mfma_f32_16x16x32_bf16 v[128:131], v[176:179], v[188:191], v[128:131]
    v_mfma_f32_16x16x32_bf16 v[132:135], v[176:179], v[192:195], v[132:135]
    s_waitcnt lgkmcnt(6)
    v_mfma_f32_16x16x32_bf16 v[80:83], v[156:159], v[188:191], v[80:83]
    v_mfma_f32_16x16x32_bf16 v[84:87], v[156:159], v[192:195], v[84:87]
    s_waitcnt lgkmcnt(4)
    v_mfma_f32_16x16x32_bf16 v[136:139], v[160:163], v[188:191], v[136:139]
    v_mfma_f32_16x16x32_bf16 v[140:143], v[160:163], v[192:195], v[140:143]
    s_waitcnt lgkmcnt(2)
    v_mfma_f32_16x16x32_bf16 v[88:91], v[164:167], v[188:191], v[88:91]
    v_mfma_f32_16x16x32_bf16 v[92:95], v[164:167], v[192:195], v[92:95]
    s_waitcnt lgkmcnt(0)
    v_mfma_f32_16x16x32_bf16 v[144:147], v[168:171], v[188:191], v[144:147]
    v_mfma_f32_16x16x32_bf16 v[148:151], v[168:171], v[192:195], v[148:151]
    s_waitcnt vmcnt(11)
    s_mov_b64 exec, 1
    ds_add_u32 v152, v153
    s_mov_b64 exec, -1
    s_nop 3
GSPIN_2:
    ds_read_b32 v154, v152
    s_waitcnt lgkmcnt(0)
    v_readfirstlane_b32 s63, v154
    s_cmp_lt_u32 s63, 8
    s_cbranch_scc1 GSPIN_2
    ds_read_b128 v[180:183], v19 offset:24576
    ds_read_b128 v[184:187], v19 offset:26624
    ds_read_b128 v[188:191], v20 offset:24576
    ds_read_b128 v[192:195], v20 offset:26624
    ds_read_b64_tr_b16 v[156:157], v31 offset:24576
    ds_read_b64_tr_b16 v[158:159], v31 offset:25472
    ds_read_b64_tr_b16 v[160:161], v31 offset:38912
    ds_read_b64_tr_b16 v[162:163], v31 offset:39808
    ds_read_b64_tr_b16 v[164:165], v32 offset:24576
    ds_read_b64_tr_b16 v[166:167], v32 offset:25472
    ds_read_b64_tr_b16 v[168:169], v32 offset:38912
    ds_read_b64_tr_b16 v[170:171], v32 offset:39808
    ds_read_b64_tr_b16 v[172:173], v33 offset:24576
    ds_read_b64_tr_b16 v[174:175], v33 offset:25472
    ds_read_b64_tr_b16 v[176:177], v33 offset:38912
    ds_read_b64_tr_b16 v[178:179], v33 offset:39808
    s_waitcnt lgkmcnt(10)
    v_mfma_f32_16x16x32_bf16 v[40:43], v[156:159], v[180:183], v[40:43]
    v_mfma_f32_16x16x32_bf16 v[44:47], v[156:159], v[184:187], v[44:47]
    s_add_u32 s58, s56, 917504
    s_add_u32 m0, s57, 45056
    s_nop 0
    buffer_load_dwordx4 v5, s[48:51], s58 offen lds
    ds_read_b64_tr_b16 v[156:157], v34 offset:24576
    ds_read_b64_tr_b16 v[158:159], v34 offset:25472
    s_waitcnt lgkmcnt(10)
    v_mfma_f32_16x16x32_bf16 v[96:99], v[160:163], v[180:183], v[96:99]
    v_mfma_f32_16x16x32_bf16 v[100:103], v[160:163], v[184:187], v[100:103]
    ds_read_b64_tr_b16 v[160:161], v34 offset:38912
    ds_read_b64_tr_b16 v[162:163], v34 offset:39808
    s_waitcnt lgkmcnt(10)
    v_mfma_f32_16x16x32_bf16 v[48:51], v[164:167], v[180:183], v[48:51]
    v_mfma_f32_16x16x32_bf16 v[52:55], v[164:167], v[184:187], v[52:55]
    s_add_u32 s59, s61, 512
    s_add_u32 m0, s62, 45056
    s_nop 0
    buffer_load_dwordx4 v16, s[36:39], s59 offen lds
    ds_read_b64_tr_b16 v[164:165], v35 offset:24576
    ds_read_b64_tr_b16 v[166:167], v35 offset:25472
    s_waitcnt lgkmcnt(10)
    v_mfma_f32_16x16x32_bf16 v[104:107], v[168:171], v[180:183], v[104:107]
    v_mfma_f32_16x16x32_bf16 v[108:111], v[168:171], v[184:187], v[108:111]
    ds_read_b64_tr_b16 v[168:169], v35 offset:38912
    ds_read_b64_tr_b16 v[170:171], v35 offset:39808
    s_waitcnt lgkmcnt(10)
    v_mfma_f32_16x16x32_bf16 v[56:59], v[172:175], v[180:183], v[56:59]
    v_mfma_f32_16x16x32_bf16 v[60:63], v[172:175], v[184:187], v[60:63]
    s_add_u32 m0, s57, 46080
    s_nop 0
    buffer_load_dwordx4 v6, s[48:51], s58 offen lds
    ds_read_b64_tr_b16 v[172:173], v36 offset:24576
    ds_read_b64_tr_b16 v[174:175], v36 offset:25472
    s_waitcnt lgkmcnt(10)
    v_mfma_f32_16x16x32_bf16 v[112:115], v[176:179], v[180:183], v[112:115]
    v_mfma_f32_16x16x32_bf16 v[116:119], v[176:179], v[184:187], v[116:119]
    ds_read_b64_tr_b16 v[176:177], v36 offset:38912
    ds_read_b64_tr_b16 v[178:179], v36 offset:39808
    s_waitcnt lgkmcnt(10)
    v_mfma_f32_16x16x32_bf16 v[64:67], v[156:159], v[180:183], v[64:67]
    v_mfma_f32_16x16x32_bf16 v[68:71], v[156:159], v[184:187], v[68:71]
    s_add_u32 s59, s61, 8704
    s_add_u32 m0, s62, 46080
    s_nop 0
    buffer_load_dwordx4 v16, s[36:39], s59 offen lds
    ds_read_b64_tr_b16 v[156:157], v37 offset:24576
    ds_read_b64_tr_b16 v[158:159], v37 offset:25472
    s_waitcnt lgkmcnt(10)
    v_mfma_f32_16x16x32_bf16 v[120:123], v[160:163], v[180:183], v[120:123]
    v_mfma_f32_16x16x32_bf16 v[124:127], v[160:163], v[184:187], v[124:127]
    ds_read_b64_tr_b16 v[160:161], v37 offset:38912
    ds_read_b64_tr_b16 v[162:163], v37 offset:39808
    s_waitcnt lgkmcnt(10)
    v_mfma_f32_16x16x32_bf16 v[72:75], v[164:167], v[180:183], v[72:75]
    v_mfma_f32_16x16x32_bf16 v[76:79], v[164:167], v[184:187], v[76:79]
    s_add_u32 m0, s57, 47104
    s_nop 0
    buffer_load_dwordx4 v7, s[48:51], s58 offen lds
    ds_read_b64_tr_b16 v[164:165], v31 offset:31744
    ds_read_b64_tr_b16 v[166:167], v31 offset:32640
    s_waitcnt lgkmcnt(10)
    v_mfma_f32_16x16x32_bf16 v[128:131], v[168:171], v[180:183], v[128:131]
    v_mfma_f32_16x16x32_bf16 v[132:135], v[168:171], v[184:187], v[132:135]
    ds_read_b64_tr_b16 v[168:169], v31 offset:46080
    ds_read_b64_tr_b16 v[170:171], v31 offset:46976
    s_waitcnt lgkmcnt(10)
    v_mfma_f32_16x16x32_bf16 v[80:83], v[172:175], v[180:183], v[80:83]
    v_mfma_f32_16x16x32_bf16 v[84:87], v[172:175], v[184:187], v[84:87]
    s_add_u32 s59, s61, 16896
    s_add_u32 m0, s62, 47104
    s_nop 0
    buffer_load_dwordx4 v16, s[36:39], s59 offen lds
    ds_read_b64_tr_b16 v[172:173], v32 offset:31744
    ds_read_b64_tr_b16 v[174:175], v32 offset:32640
    s_waitcnt lgkmcnt(10)
    v_mfma_f32_16x16x32_bf16 v[136:139], v[176:179], v[180:183], v[136:139]
    v_mfma_f32_16x16x32_bf16 v[140:143], v[176:179], v[184:187], v[140:143]
    ds_read_b64_tr_b16 v[176:177], v32 offset:46080
    ds_read_b64_tr_b16 v[178:179], v32 offset:46976
    s_waitcnt lgkmcnt(10)
    v_mfma_f32_16x16x32_bf16 v[88:91], v[156:159], v[180:183], v[88:91]
    v_mfma_f32_16x16x32_bf16 v[92:95], v[156:159], v[184:187], v[92:95]
    s_add_u32 m0, s57, 48128
    s_nop 0
    buffer_load_dwordx4 v8, s[48:51], s58 offen lds
    ds_read_b64_tr_b16 v[156:157], v33 offset:31744
    ds_read_b64_tr_b16 v[158:159], v33 offset:32640
    s_waitcnt lgkmcnt(10)
    v_mfma_f32_16x16x32_bf16 v[144:147], v[160:163], v[180:183], v[144:147]
    v_mfma_f32_16x16x32_bf16 v[148:151], v[160:163], v[184:187], v[148:151]
    ds_read_b64_tr_b16 v[160:161], v33 offset:46080
    ds_read_b64_tr_b16 v[162:163], v33 offset:46976
    s_waitcnt lgkmcnt(10)
    v_mfma_f32_16x16x32_bf16 v[40:43], v[164:167], v[188:191], v[40:43]
    v_mfma_f32_16x16x32_bf16 v[44:47], v[164:167], v[192:195], v[44:47]
    s_add_u32 s59, s61, 25088
    s_add_u32 m0, s62, 48128
    s_nop 0
    buffer_load_dwordx4 v16, s[36:39], s59 offen lds
    ds_read_b64_tr_b16 v[164:165], v34 offset:31744
    ds_read_b64_tr_b16 v[166:167], v34 offset:32640
    s_waitcnt lgkmcnt(10)
    v_mfma_f32_16x16x32_bf16 v[96:99], v[168:171], v[188:191], v[96:99]
    v_mfma_f32_16x16x32_bf16 v[100:103], v[168:171], v[192:195], v[100:103]
    ds_read_b64_tr_b16 v[168:169], v34 offset:46080
    ds_read_b64_tr_b16 v[170:171], v34 offset:46976
    s_waitcnt lgkmcnt(10)
    v_mfma_f32_16x16x32_bf16 v[48:51], v[172:175], v[188:191], v[48:51]
    v_mfma_f32_16x16x32_bf16 v[52:55], v[172:175], v[192:195], v[52:55]
    s_add_u32 m0, s57, 49152
    s_nop 0
    buffer_load_dwordx4 v9, s[48:51], s58 offen lds
    ds_read_b64_tr_b16 v[172:173], v35 offset:31744
    ds_read_b64_tr_b16 v[174:175], v35 offset:32640
    s_waitcnt lgkmcnt(10)
    v_mfma_f32_16x16x32_bf16 v[104:107], v[176:179], v[188:191], v[104:107]
    v_mfma_f32_16x16x32_bf16 v[108:111], v[176:179], v[192:195], v[108:111]
    ds_read_b64_tr_b16 v[176:177], v35 offset:46080
    ds_read_b64_tr_b16 v[178:179], v35 offset:46976
    s_waitcnt lgkmcnt(10)
    v_mfma_f32_16x16x32_bf16 v[56:59], v[156:159], v[188:191], v[56:59]
    v_mfma_f32_16x16x32_bf16 v[60:63], v[156:159], v[192:195], v[60:63]
    s_add_u32 m0, s57, 50176
    s_nop 0
    buffer_load_dwordx4 v10, s[48:51], s58 offen lds
    ds_read_b64_tr_b16 v[156:157], v36 offset:31744
    ds_read_b64_tr_b16 v[158:159], v36 offset:32640
    s_waitcnt lgkmcnt(10)
    v_mfma_f32_16x16x32_bf16 v[112:115], v[160:163], v[188:191], v[112:115]
    v_mfma_f32_16x16x32_bf16 v[116:119], v[160:163], v[192:195], v[116:119]
    ds_read_b64_tr_b16 v[160:161], v36 offset:46080
    ds_read_b64_tr_b16 v[162:163], v36 offset:46976
    s_waitcnt lgkmcnt(10)
    v_mfma_f32_16x16x32_bf16 v[64:67], v[164:167], v[188:191], v[64:67]
    v_mfma_f32_16x16x32_bf16 v[68:71], v[164:167], v[192:195], v[68:71]
    s_add_u32 m0, s57, 51200
    s_nop 0
    buffer_load_dwordx4 v11, s[48:51], s58 offen lds
    ds_read_b64_tr_b16 v[164:165], v37 offset:31744
    ds_read_b64_tr_b16 v[166:167], v37 offset:32640
    s_waitcnt lgkmcnt(10)
    v_mfma_f32_16x16x32_bf16 v[120:123], v[168:171], v[188:191], v[120:123]
    v_mfma_f32_16x16x32_bf16 v[124:127], v[168:171], v[192:195], v[124:127]
    ds_read_b64_tr_b16 v[168:169], v37 offset:46080
    ds_read_b64_tr_b16 v[170:171], v37 offset:46976
    s_waitcnt lgkmcnt(10)
    v_mfma_f32_16x16x32_bf16 v[72:75], v[172:175], v[188:191], v[72:75]
    v_mfma_f32_16x16x32_bf16 v[76:79], v[172:175], v[192:195], v[76:79]
    s_waitcnt lgkmcnt(8)
    v_mfma_f32_16x16x32_bf16 v[128:131], v[176:179], v[188:191], v[128:131]
    v_mfma_f32_16x16x32_bf16 v[132:135], v[176:179], v[192:195], v[132:135]
    s_waitcnt lgkmcnt(6)
    v_mfma_f32_16x16x32_bf16 v[80:83], v[156:159], v[188:191], v[80:83]
    v_mfma_f32_16x16x32_bf16 v[84:87], v[156:159], v[192:195], v[84:87]
    s_waitcnt lgkmcnt(4)
    v_mfma_f32_16x16x32_bf16 v[136:139], v[160:163], v[188:191], v[136:139]
    v_mfma_f32_16x16x32_bf16 v[140:143], v[160:163], v[192:195], v[140:143]
    s_waitcnt lgkmcnt(2)
    v_mfma_f32_16x16x32_bf16 v[88:91], v[164:167], v[188:191], v[88:91]
    v_mfma_f32_16x16x32_bf16 v[92:95], v[164:167], v[192:195], v[92:95]
    s_waitcnt lgkmcnt(0)
    v_mfma_f32_16x16x32_bf16 v[144:147], v[168:171], v[188:191], v[144:147]
    v_mfma_f32_16x16x32_bf16 v[148:151], v[168:171], v[192:195], v[148:151]
    s_waitcnt vmcnt(11)
    s_mov_b64 exec, 1
    ds_add_u32 v152, v153
    s_mov_b64 exec, -1
    s_nop 3
GSPIN_3:
    ds_read_b32 v154, v152
    s_waitcnt lgkmcnt(0)
    v_readfirstlane_b32 s63, v154
    s_cmp_lt_u32 s63, 12
    s_cbranch_scc1 GSPIN_3
    ds_read_b128 v[180:183], v17 offset:0
    ds_read_b128 v[184:187], v17 offset:2048
    ds_read_b128 v[188:191], v18 offset:0
    ds_read_b128 v[192:195], v18 offset:2048
    ds_read_b64_tr_b16 v[156:157], v23 offset:0
    ds_read_b64_tr_b16 v[158:159], v23 offset:896
    ds_read_b64_tr_b16 v[160:161], v23 offset:14336
    ds_read_b64_tr_b16 v[162:163], v23 offset:15232
    ds_read_b64_tr_b16 v[164:165], v24 offset:0
    ds_read_b64_tr_b16 v[166:167], v24 offset:896
    ds_read_b64_tr_b16 v[168:169], v24 offset:14336
    ds_read_b64_tr_b16 v[170:171], v24 offset:15232
    ds_read_b64_tr_b16 v[172:173], v25 offset:0
    ds_read_b64_tr_b16 v[174:175], v25 offset:896
    ds_read_b64_tr_b16 v[176:177], v25 offset:14336
    ds_read_b64_tr_b16 v[178:179], v25 offset:15232
    s_waitcnt lgkmcnt(10)
    v_mfma_f32_16x16x32_bf16 v[40:43], v[156:159], v[180:183], v[40:43]
    v_mfma_f32_16x16x32_bf16 v[44:47], v[156:159], v[184:187], v[44:47]
    s_add_u32 s58, s56, 1146880
    s_add_u32 m0, s57, 90112
    s_nop 0
    buffer_load_dwordx4 v5, s[48:51], s58 offen lds
    ds_read_b64_tr_b16 v[156:157], v26 offset:0
    ds_read_b64_tr_b16 v[158:159], v26 offset:896
    s_waitcnt lgkmcnt(10)
    v_mfma_f32_16x16x32_bf16 v[96:99], v[160:163], v[180:183], v[96:99]
    v_mfma_f32_16x16x32_bf16 v[100:103], v[160:163], v[184:187], v[100:103]
    ds_read_b64_tr_b16 v[160:161], v26 offset:14336
    ds_read_b64_tr_b16 v[162:163], v26 offset:15232
    s_waitcnt lgkmcnt(10)
    v_mfma_f32_16x16x32_bf16 v[48:51], v[164:167], v[180:183], v[48:51]
    v_mfma_f32_16x16x32_bf16 v[52:55], v[164:167], v[184:187], v[52:55]
    s_add_u32 s59, s61, 640
    s_add_u32 m0, s62, 90112
    s_nop 0
    buffer_load_dwordx4 v16, s[36:39], s59 offen lds
    ds_read_b64_tr_b16 v[164:165], v27 offset:0
    ds_read_b64_tr_b16 v[166:167], v27 offset:896
    s_waitcnt lgkmcnt(10)
    v_mfma_f32_16x16x32_bf16 v[104:107], v[168:171], v[180:183], v[104:107]
    v_mfma_f32_16x16x32_bf16 v[108:111], v[168:171], v[184:187], v[108:111]
    ds_read_b64_tr_b16 v[168:169], v27 offset:14336
    ds_read_b64_tr_b16 v[170:171], v27 offset:15232
    s_waitcnt lgkmcnt(10)
    v_mfma_f32_16x16x32_bf16 v[56:59], v[172:175], v[180:183], v[56:59]
    v_mfma_f32_16x16x32_bf16 v[60:63], v[172:175], v[184:187], v[60:63]
    s_add_u32 m0, s57, 91136
    s_nop 0
    buffer_load_dwordx4 v6, s[48:51], s58 offen lds
    ds_read_b64_tr_b16 v[172:173], v28 offset:0
    ds_read_b64_tr_b16 v[174:175], v28 offset:896
    s_waitcnt lgkmcnt(10)
    v_mfma_f32_16x16x32_bf16 v[112:115], v[176:179], v[180:183], v[112:115]
    v_mfma_f32_16x16x32_bf16 v[116:119], v[176:179], v[184:187], v[116:119]
    ds_read_b64_tr_b16 v[176:177], v28 offset:14336
    ds_read_b64_tr_b16 v[178:179], v28 offset:15232
    s_waitcnt lgkmcnt(10)
    v_mfma_f32_16x16x32_bf16 v[64:67], v[156:159], v[180:183], v[64:67]
    v_mfma_f32_16x16x32_bf16 v[68:71], v[156:159], v[184:187], v[68:71]
    s_add_u32 s59, s61, 8832
    s_add_u32 m0, s62, 91136
    s_nop 0
    buffer_load_dwordx4 v16, s[36:39], s59 offen lds
    ds_read_b64_tr_b16 v[156:157], v29 offset:0
    ds_read_b64_tr_b16 v[158:159], v29 offset:896
    s_waitcnt lgkmcnt(10)
    v_mfma_f32_16x16x32_bf16 v[120:123], v[160:163], v[180:183], v[120:123]
    v_mfma_f32_16x16x32_bf16 v[124:127], v[160:163], v[184:187], v[124:127]
    ds_read_b64_tr_b16 v[160:161], v29 offset:14336
    ds_read_b64_tr_b16 v[162:163], v29 offset:15232
    s_waitcnt lgkmcnt(10)
    v_mfma_f32_16x16x32_bf16 v[72:75], v[164:167], v[180:183], v[72:75]
    v_mfma_f32_16x16x32_bf16 v[76:79], v[164:167], v[184:187], v[76:79]
    s_add_u32 m0, s57, 92160
    s_nop 0
    buffer_load_dwordx4 v7, s[48:51], s58 offen lds
    ds_read_b64_tr_b16 v[164:165], v23 offset:7168
    ds_read_b64_tr_b16 v[166:167], v23 offset:8064
    s_waitcnt lgkmcnt(10)
    v_mfma_f32_16x16x32_bf16 v[128:131], v[168:171], v[180:183], v[128:131]
    v_mfma_f32_16x16x32_bf16 v[132:135], v[168:171], v[184:187], v[132:135]
    ds_read_b64_tr_b16 v[168:169], v23 offset:21504
    ds_read_b64_tr_b16 v[170:171], v23 offset:22400
    s_waitcnt lgkmcnt(10)
    v_mfma_f32_16x16x32_bf16 v[80:83], v[172:175], v[180:183], v[80:83]
    v_mfma_f32_16x16x32_bf16 v[84:87], v[172:175], v[184:187], v[84:87]
    s_add_u32 s59, s61, 17024
    s_add_u32 m0, s62, 92160
    s_nop 0
    buffer_load_dwordx4 v16, s[36:39], s59 offen lds
    ds_read_b64_tr_b16 v[172:173], v24 offset:7168
    ds_read_b64_tr_b16 v[174:175], v24 offset:8064
    s_waitcnt lgkmcnt(10)
    v_mfma_f32_16x16x32_bf16 v[136:139], v[176:179], v[180:183], v[136:139]
    v_mfma_f32_16x16x32_bf16 v[140:143], v[176:179], v[184:187], v[140:143]
    ds_read_b64_tr_b16 v[176:177], v24 offset:21504
    ds_read_b64_tr_b16 v[178:179], v24 offset:22400
    s_waitcnt lgkmcnt(10)
    v_mfma_f32_16x16x32_bf16 v[88:91], v[156:159], v[180:183], v[88:91]
    v_mfma_f32_16x16x32_bf16 v[92:95], v[156:159], v[184:187], v[92:95]
    s_add_u32 m0, s57, 93184
    s_nop 0
    buffer_load_dwordx4 v8, s[48:51], s58 offen lds
    ds_read_b64_tr_b16 v[156:157], v25 offset:7168
    ds_read_b64_tr_b16 v[158:159], v25 offset:8064
    s_waitcnt lgkmcnt(10)
    v_mfma_f32_16x16x32_bf16 v[144:147], v[160:163], v[180:183], v[144:147]
    v_mfma_f32_16x16x32_bf16 v[148:151], v[160:163], v[184:187], v[148:151]
    ds_read_b64_tr_b16 v[160:161], v25 offset:21504
    ds_read_b64_tr_b16 v[162:163], v25 offset:22400
    s_waitcnt lgkmcnt(10)
    v_mfma_f32_16x16x32_bf16 v[40:43], v[164:167], v[188:191], v[40:43]
    v_mfma_f32_16x16x32_bf16 v[44:47], v[164:167], v[192:195], v[44:47]
    s_add_u32 s59, s61, 25216
    s_add_u32 m0, s62, 93184
    s_nop 0
    buffer_load_dwordx4 v16, s[36:39], s59 offen lds
    ds_read_b64_tr_b16 v[164:165], v26 offset:7168
    ds_read_b64_tr_b16 v[166:167], v26 offset:8064
    s_waitcnt lgkmcnt(10)
    v_mfma_f32_16x16x32_bf16 v[96:99], v[168:171], v[188:191], v[96:99]
    v_mfma_f32_16x16x32_bf16 v[100:103], v[168:171], v[192:195], v[100:103]
    ds_read_b64_tr_b16 v[168:169], v26 offset:21504
    ds_read_b64_tr_b16 v[170:171], v26 offset:22400
    s_waitcnt lgkmcnt(10)
    v_mfma_f32_16x16x32_bf16 v[48:51], v[172:175], v[188:191], v[48:51]
    v_mfma_f32_16x16x32_bf16 v[52:55], v[172:175], v[192:195], v[52:55]
    s_add_u32 m0, s57, 94208
    s_nop 0
    buffer_load_dwordx4 v9, s[48:51], s58 offen lds
    ds_read_b64_tr_b16 v[172:173], v27 offset:7168
    ds_read_b64_tr_b16 v[174:175], v27 offset:8064
    s_waitcnt lgkmcnt(10)
    v_mfma_f32_16x16x32_bf16 v[104:107], v[176:179], v[188:191], v[104:107]
    v_mfma_f32_16x16x32_bf16 v[108:111], v[176:179], v[192:195], v[108:111]
    ds_read_b64_tr_b16 v[176:177], v27 offset:21504
    ds_read_b64_tr_b16 v[178:179], v27 offset:22400
    s_waitcnt lgkmcnt(10)
    v_mfma_f32_16x16x32_bf16 v[56:59], v[156:159], v[188:191], v[56:59]
    v_mfma_f32_16x16x32_bf16 v[60:63], v[156:159], v[192:195], v[60:63]
    s_add_u32 m0, s57, 95232
    s_nop 0
    buffer_load_dwordx4 v10, s[48:51], s58 offen lds
    ds_read_b64_tr_b16 v[156:157], v28 offset:7168
    ds_read_b64_tr_b16 v[158:159], v28 offset:8064
    s_waitcnt lgkmcnt(10)
    v_mfma_f32_16x16x32_bf16 v[112:115], v[160:163], v[188:191], v[112:115]
    v_mfma_f32_16x16x32_bf16 v[116:119], v[160:163], v[192:195], v[116:119]
    ds_read_b64_tr_b16 v[160:161], v28 offset:21504
    ds_read_b64_tr_b16 v[162:163], v28 offset:22400
    s_waitcnt lgkmcnt(10)
    v_mfma_f32_16x16x32_bf16 v[64:67], v[164:167], v[188:191], v[64:67]
    v_mfma_f32_16x16x32_bf16 v[68:71], v[164:167], v[192:195], v[68:71]
    s_add_u32 m0, s57, 96256
    s_nop 0
    buffer_load_dwordx4 v11, s[48:51], s58 offen lds
    ds_read_b64_tr_b16 v[164:165], v29 offset:7168
    ds_read_b64_tr_b16 v[166:167], v29 offset:8064
    s_waitcnt lgkmcnt(10)
    v_mfma_f32_16x16x32_bf16 v[120:123], v[168:171], v[188:191], v[120:123]
    v_mfma_f32_16x16x32_bf16 v[124:127], v[168:171], v[192:195], v[124:127]
    ds_read_b64_tr_b16 v[168:169], v29 offset:21504
    ds_read_b64_tr_b16 v[170:171], v29 offset:22400
    s_waitcnt lgkmcnt(10)
    v_mfma_f32_16x16x32_bf16 v[72:75], v[172:175], v[188:191], v[72:75]
    v_mfma_f32_16x16x32_bf16 v[76:79], v[172:175], v[192:195], v[76:79]
    s_waitcnt lgkmcnt(8)
    v_mfma_f32_16x16x32_bf16 v[128:131], v[176:179], v[188:191], v[128:131]
    v_mfma_f32_16x16x32_bf16 v[132:135], v[176:179], v[192:195], v[132:135]
    s_waitcnt lgkmcnt(6)
    v_mfma_f32_16x16x32_bf16 v[80:83], v[156:159], v[188:191], v[80:83]
    v_mfma_f32_16x16x32_bf16 v[84:87], v[156:159], v[192:195], v[84:87]
    s_waitcnt lgkmcnt(4)
    v_mfma_f32_16x16x32_bf16 v[136:139], v[160:163], v[188:191], v[136:139]
    v_mfma_f32_16x16x32_bf16 v[140:143], v[160:163], v[192:195], v[140:143]
    s_waitcnt lgkmcnt(2)
    v_mfma_f32_16x16x32_bf16 v[88:91], v[164:167], v[188:191], v[88:91]
    v_mfma_f32_16x16x32_bf16 v[92:95], v[164:167], v[192:195], v[92:95]
    s_waitcnt lgkmcnt(0)
    v_mfma_f32_16x16x32_bf16 v[144:147], v[168:171], v[188:191], v[144:147]
    v_mfma_f32_16x16x32_bf16 v[148:151], v[168:171], v[192:195], v[148:151]
    s_waitcnt vmcnt(11)
    s_mov_b64 exec, 1
    ds_add_u32 v152, v153
    s_mov_b64 exec, -1
    s_nop 3
GSPIN_4:
    ds_read_b32 v154, v152
    s_waitcnt lgkmcnt(0)
    v_readfirstlane_b32 s63, v154
    s_cmp_lt_u32 s63, 16
    s_cbranch_scc1 GSPIN_4
    ds_read_b128 v[180:183], v17 offset:45056
    ds_read_b128 v[184:187], v17 offset:47104
    ds_read_b128 v[188:191], v18 offset:45056
    ds_read_b128 v[192:195], v18 offset:47104
    ds_read_b64_tr_b16 v[156:157], v23 offset:45056
    ds_read_b64_tr_b16 v[158:159], v23 offset:45952
    ds_read_b64_tr_b16 v[160:161], v23 offset:59392
    ds_read_b64_tr_b16 v[162:163], v23 offset:60288
    ds_read_b64_tr_b16 v[164:165], v24 offset:45056
    ds_read_b64_tr_b16 v[166:167], v24 offset:45952
    ds_read_b64_tr_b16 v[168:169], v24 offset:59392
    ds_read_b64_tr_b16 v[170:171], v24 offset:60288
    ds_read_b64_tr_b16 v[172:173], v25 offset:45056
    ds_read_b64_tr_b16 v[174:175], v25 offset:45952
    ds_read_b64_tr_b16 v[176:177], v25 offset:59392
    ds_read_b64_tr_b16 v[178:179], v25 offset:60288
    s_waitcnt lgkmcnt(10)
    v_mfma_f32_16x16x32_bf16 v[40:43], v[156:159], v[180:183], v[40:43]
    v_mfma_f32_16x16x32_bf16 v[44:47], v[156:159], v[184:187], v[44:47]
    s_add_u32 s58, s56, 1376256
    s_add_u32 m0, s57, 0
    s_nop 0
    buffer_load_dwordx4 v5, s[48:51], s58 offen lds
    ds_read_b64_tr_b16 v[156:157], v26 offset:45056
    ds_read_b64_tr_b16 v[158:159], v26 offset:45952
    s_waitcnt lgkmcnt(10)
    v_mfma_f32_16x16x32_bf16 v[96:99], v[160:163], v[180:183], v[96:99]
    v_mfma_f32_16x16x32_bf16 v[100:103], v[160:163], v[184:187], v[100:103]
    ds_read_b64_tr_b16 v[160:161], v26 offset:59392
    ds_read_b64_tr_b16 v[162:163], v26 offset:60288
    s_waitcnt lgkmcnt(10)
    v_mfma_f32_16x16x32_bf16 v[48:51], v[164:167], v[180:183], v[48:51]
    v_mfma_f32_16x16x32_bf16 v[52:55], v[164:167], v[184:187], v[52:55]
    s_add_u32 s59, s61, 768
    s_add_u32 m0, s62, 0
    s_nop 0
    buffer_load_dwordx4 v16, s[36:39], s59 offen lds
    ds_read_b64_tr_b16 v[164:165], v27 offset:45056
    ds_read_b64_tr_b16 v[166:167], v27 offset:45952
    s_waitcnt lgkmcnt(10)
    v_mfma_f32_16x16x32_bf16 v[104:107], v[168:171], v[180:183], v[104:107]
    v_mfma_f32_16x16x32_bf16 v[108:111], v[168:171], v[184:187], v[108:111]
    ds_read_b64_tr_b16 v[168:169], v27 offset:59392
    ds_read_b64_tr_b16 v[170:171], v27 offset:60288
    s_waitcnt lgkmcnt(10)
    v_mfma_f32_16x16x32_bf16 v[56:59], v[172:175], v[180:183], v[56:59]
    v_mfma_f32_16x16x32_bf16 v[60:63], v[172:175], v[184:187], v[60:63]
    s_add_u32 m0, s57, 1024
    s_nop 0
    buffer_load_dwordx4 v6, s[48:51], s58 offen lds
    ds_read_b64_tr_b16 v[172:173], v28 offset:45056
    ds_read_b64_tr_b16 v[174:175], v28 offset:45952
    s_waitcnt lgkmcnt(10)
    v_mfma_f32_16x16x32_bf16 v[112:115], v[176:179], v[180:183], v[112:115]
    v_mfma_f32_16x16x32_bf16 v[116:119], v[176:179], v[184:187], v[116:119]
    ds_read_b64_tr_b16 v[176:177], v28 offset:59392
    ds_read_b64_tr_b16 v[178:179], v28 offset:60288
    s_waitcnt lgkmcnt(10)
    v_mfma_f32_16x16x32_bf16 v[64:67], v[156:159], v[180:183], v[64:67]
    v_mfma_f32_16x16x32_bf16 v[68:71], v[156:159], v[184:187], v[68:71]
    s_add_u32 s59, s61, 8960
    s_add_u32 m0, s62, 1024
    s_nop 0
    buffer_load_dwordx4 v16, s[36:39], s59 offen lds
    ds_read_b64_tr_b16 v[156:157], v29 offset:45056
    ds_read_b64_tr_b16 v[158:159], v29 offset:45952
    s_waitcnt lgkmcnt(10)
    v_mfma_f32_16x16x32_bf16 v[120:123], v[160:163], v[180:183], v[120:123]
    v_mfma_f32_16x16x32_bf16 v[124:127], v[160:163], v[184:187], v[124:127]
    ds_read_b64_tr_b16 v[160:161], v29 offset:59392
    ds_read_b64_tr_b16 v[162:163], v29 offset:60288
    s_waitcnt lgkmcnt(10)
    v_mfma_f32_16x16x32_bf16 v[72:75], v[164:167], v[180:183], v[72:75]
    v_mfma_f32_16x16x32_bf16 v[76:79], v[164:167], v[184:187], v[76:79]
    s_add_u32 m0, s57, 2048
    s_nop 0
    buffer_load_dwordx4 v7, s[48:51], s58 offen lds
    ds_read_b64_tr_b16 v[164:165], v23 offset:52224
    ds_read_b64_tr_b16 v[166:167], v23 offset:53120
    s_waitcnt lgkmcnt(10)
    v_mfma_f32_16x16x32_bf16 v[128:131], v[168:171], v[180:183], v[128:131]
    v_mfma_f32_16x16x32_bf16 v[132:135], v[168:171], v[184:187], v[132:135]
    ds_read_b64_tr_b16 v[168:169], v31 offset:1024
    ds_read_b64_tr_b16 v[170:171], v31 offset:1920
    s_waitcnt lgkmcnt(10)
    v_mfma_f32_16x16x32_bf16 v[80:83], v[172:175], v[180:183], v[80:83]
    v_mfma_f32_16x16x32_bf16 v[84:87], v[172:175], v[184:187], v[84:87]
    s_add_u32 s59, s61, 17152
    s_add_u32 m0, s62, 2048
    s_nop 0
    buffer_load_dwordx4 v16, s[36:39], s59 offen lds
    ds_read_b64_tr_b16 v[172:173], v24 offset:52224
    ds_read_b64_tr_b16 v[174:175], v24 offset:53120
    s_waitcnt lgkmcnt(10)
    v_mfma_f32_16x16x32_bf16 v[136:139], v[176:179], v[180:183], v[136:139]
    v_mfma_f32_16x16x32_bf16 v[140:143], v[176:179], v[184:187], v[140:143]
    ds_read_b64_tr_b16 v[176:177], v32 offset:1024
    ds_read_b64_tr_b16 v[178:179], v32 offset:1920
    s_waitcnt lgkmcnt(10)
    v_mfma_f32_16x16x32_bf16 v[88:91], v[156:159], v[180:183], v[88:91]
    v_mfma_f32_16x16x32_bf16 v[92:95], v[156:159], v[184:187], v[92:95]
    s_add_u32 m0, s57, 3072
    s_nop 0
    buffer_load_dwordx4 v8, s[48:51], s58 offen lds
    ds_read_b64_tr_b16 v[156:157], v25 offset:52224
    ds_read_b64_tr_b16 v[158:159], v25 offset:53120
    s_waitcnt lgkmcnt(10)
    v_mfma_f32_16x16x32_bf16 v[144:147], v[160:163], v[180:183], v[144:147]
    v_mfma_f32_16x16x32_bf16 v[148:151], v[160:163], v[184:187], v[148:151]
    ds_read_b64_tr_b16 v[160:161], v33 offset:1024
    ds_read_b64_tr_b16 v[162:163], v33 offset:1920
    s_waitcnt lgkmcnt(10)
    v_mfma_f32_16x16x32_bf16 v[40:43], v[164:167], v[188:191], v[40:43]
    v_mfma_f32_16x16x32_bf16 v[44:47], v[164:167], v[192:195], v[44:47]
    s_add_u32 s59, s61, 25344
    s_add_u32 m0, s62, 3072
    s_nop 0
    buffer_load_dwordx4 v16, s[36:39], s59 offen lds
    ds_read_b64_tr_b16 v[164:165], v26 offset:52224
    ds_read_b64_tr_b16 v[166:167], v26 offset:53120
    s_waitcnt lgkmcnt(10)
    v_mfma_f32_16x16x32_bf16 v[96:99], v[168:171], v[188:191], v[96:99]
    v_mfma_f32_16x16x32_bf16 v[100:103], v[168:171], v[192:195], v[100:103]
    ds_read_b64_tr_b16 v[168:169], v34 offset:1024
    ds_read_b64_tr_b16 v[170:171], v34 offset:1920
    s_waitcnt lgkmcnt(10)
    v_mfma_f32_16x16x32_bf16 v[48:51], v[172:175], v[188:191], v[48:51]
    v_mfma_f32_16x16x32_bf16 v[52:55], v[172:175], v[192:195], v[52:55]
    s_add_u32 m0, s57, 4096
    s_nop 0
    buffer_load_dwordx4 v9, s[48:51], s58 offen lds
    ds_read_b64_tr_b16 v[172:173], v27 offset:52224
    ds_read_b64_tr_b16 v[174:175], v27 offset:53120
    s_waitcnt lgkmcnt(10)
    v_mfma_f32_16x16x32_bf16 v[104:107], v[176:179], v[188:191], v[104:107]
    v_mfma_f32_16x16x32_bf16 v[108:111], v[176:179], v[192:195], v[108:111]
    ds_read_b64_tr_b16 v[176:177], v35 offset:1024
    ds_read_b64_tr_b16 v[178:179], v35 offset:1920
    s_waitcnt lgkmcnt(10)
    v_mfma_f32_16x16x32_bf16 v[56:59], v[156:159], v[188:191], v[56:59]
    v_mfma_f32_16x16x32_bf16 v[60:63], v[156:159], v[192:195], v[60:63]
    s_add_u32 m0, s57, 5120
    s_nop 0
    buffer_load_dwordx4 v10, s[48:51], s58 offen lds
    ds_read_b64_tr_b16 v[156:157], v28 offset:52224
    ds_read_b64_tr_b16 v[158:159], v28 offset:53120
    s_waitcnt lgkmcnt(10)
    v_mfma_f32_16x16x32_bf16 v[112:115], v[160:163], v[188:191], v[112:115]
    v_mfma_f32_16x16x32_bf16 v[116:119], v[160:163], v[192:195], v[116:119]
    ds_read_b64_tr_b16 v[160:161], v36 offset:1024
    ds_read_b64_tr_b16 v[162:163], v36 offset:1920
    s_waitcnt lgkmcnt(10)
    v_mfma_f32_16x16x32_bf16 v[64:67], v[164:167], v[188:191], v[64:67]
    v_mfma_f32_16x16x32_bf16 v[68:71], v[164:167], v[192:195], v[68:71]
    s_add_u32 m0, s57, 6144
    s_nop 0
    buffer_load_dwordx4 v11, s[48:51], s58 offen lds
    ds_read_b64_tr_b16 v[164:165], v29 offset:52224
    ds_read_b64_tr_b16 v[166:167], v29 offset:53120
    s_waitcnt lgkmcnt(10)
    v_mfma_f32_16x16x32_bf16 v[120:123], v[168:171], v[188:191], v[120:123]
    v_mfma_f32_16x16x32_bf16 v[124:127], v[168:171], v[192:195], v[124:127]
    ds_read_b64_tr_b16 v[168:169], v37 offset:1024
    ds_read_b64_tr_b16 v[170:171], v37 offset:1920
    s_waitcnt lgkmcnt(10)
    v_mfma_f32_16x16x32_bf16 v[72:75], v[172:175], v[188:191], v[72:75]
    v_mfma_f32_16x16x32_bf16 v[76:79], v[172:175], v[192:195], v[76:79]
    s_waitcnt lgkmcnt(8)
    v_mfma_f32_16x16x32_bf16 v[128:131], v[176:179], v[188:191], v[128:131]
    v_mfma_f32_16x16x32_bf16 v[132:135], v[176:179], v[192:195], v[132:135]
    s_waitcnt lgkmcnt(6)
    v_mfma_f32_16x16x32_bf16 v[80:83], v[156:159], v[188:191], v[80:83]
    v_mfma_f32_16x16x32_bf16 v[84:87], v[156:159], v[192:195], v[84:87]
    s_waitcnt lgkmcnt(4)
    v_mfma_f32_16x16x32_bf16 v[136:139], v[160:163], v[188:191], v[136:139]
    v_mfma_f32_16x16x32_bf16 v[140:143], v[160:163], v[192:195], v[140:143]
    s_waitcnt lgkmcnt(2)
    v_mfma_f32_16x16x32_bf16 v[88:91], v[164:167], v[188:191], v[88:91]
    v_mfma_f32_16x16x32_bf16 v[92:95], v[164:167], v[192:195], v[92:95]
    s_waitcnt lgkmcnt(0)
    v_mfma_f32_16x16x32_bf16 v[144:147], v[168:171], v[188:191], v[144:147]
    v_mfma_f32_16x16x32_bf16 v[148:151], v[168:171], v[192:195], v[148:151]
    s_waitcnt vmcnt(11)
    s_mov_b64 exec, 1
    ds_add_u32 v152, v153
    s_mov_b64 exec, -1
    s_nop 3
GSPIN_5:
    ds_read_b32 v154, v152
    s_waitcnt lgkmcnt(0)
    v_readfirstlane_b32 s63, v154
    s_cmp_lt_u32 s63, 20
    s_cbranch_scc1 GSPIN_5
    ds_read_b128 v[180:183], v19 offset:24576
    ds_read_b128 v[184:187], v19 offset:26624
    ds_read_b128 v[188:191], v20 offset:24576
    ds_read_b128 v[192:195], v20 offset:26624
    ds_read_b64_tr_b16 v[156:157], v31 offset:24576
    ds_read_b64_tr_b16 v[158:159], v31 offset:25472
    ds_read_b64_tr_b16 v[160:161], v31 offset:38912
    ds_read_b64_tr_b16 v[162:163], v31 offset:39808
    ds_read_b64_tr_b16 v[164:165], v32 offset:24576
    ds_read_b64_tr_b16 v[166:167], v32 offset:25472
    ds_read_b64_tr_b16 v[168:169], v32 offset:38912
    ds_read_b64_tr_b16 v[170:171], v32 offset:39808
    ds_read_b64_tr_b16 v[172:173], v33 offset:24576
    ds_read_b64_tr_b16 v[174:175], v33 offset:25472
    ds_read_b64_tr_b16 v[176:177], v33 offset:38912
    ds_read_b64_tr_b16 v[178:179], v33 offset:39808
    s_waitcnt lgkmcnt(10)
    v_mfma_f32_16x16x32_bf16 v[40:43], v[156:159], v[180:183], v[40:43]
    v_mfma_f32_16x16x32_bf16 v[44:47], v[156:159], v[184:187], v[44:47]
    s_add_u32 s58, s56, 1605632
    s_add_u32 m0, s57, 45056
    s_nop 0
    buffer_load_dwordx4 v5, s[48:51], s58 offen lds
    ds_read_b64_tr_b16 v[156:157], v34 offset:24576
    ds_read_b64_tr_b16 v[158:159], v34 offset:25472
    s_waitcnt lgkmcnt(10)
    v_mfma_f32_16x16x32_bf16 v[96:99], v[160:163], v[180:183], v[96:99]
    v_mfma_f32_16x16x32_bf16 v[100:103], v[160:163], v[184:187], v[100:103]
    ds_read_b64_tr_b16 v[160:161], v34 offset:38912
    ds_read_b64_tr_b16 v[162:163], v34 offset:39808
    s_waitcnt lgkmcnt(10)
    v_mfma_f32_16x16x32_bf16 v[48:51], v[164:167], v[180:183], v[48:51]
    v_mfma_f32_16x16x32_bf16 v[52:55], v[164:167], v[184:187], v[52:55]
    s_add_u32 s59, s61, 896
    s_add_u32 m0, s62, 45056
    s_nop 0
    buffer_load_dwordx4 v16, s[36:39], s59 offen lds
    ds_read_b64_tr_b16 v[164:165], v35 offset:24576
    ds_read_b64_tr_b16 v[166:167], v35 offset:25472
    s_waitcnt lgkmcnt(10)
    v_mfma_f32_16x16x32_bf16 v[104:107], v[168:171], v[180:183], v[104:107]
    v_mfma_f32_16x16x32_bf16 v[108:111], v[168:171], v[184:187], v[108:111]
    ds_read_b64_tr_b16 v[168:169], v35 offset:38912
    ds_read_b64_tr_b16 v[170:171], v35 offset:39808
    s_waitcnt lgkmcnt(10)
    v_mfma_f32_16x16x32_bf16 v[56:59], v[172:175], v[180:183], v[56:59]
    v_mfma_f32_16x16x32_bf16 v[60:63], v[172:175], v[184:187], v[60:63]
    s_add_u32 m0, s57, 46080
    s_nop 0
    buffer_load_dwordx4 v6, s[48:51], s58 offen lds
    ds_read_b64_tr_b16 v[172:173], v36 offset:24576
    ds_read_b64_tr_b16 v[174:175], v36 offset:25472
    s_waitcnt lgkmcnt(10)
    v_mfma_f32_16x16x32_bf16 v[112:115], v[176:179], v[180:183], v[112:115]
    v_mfma_f32_16x16x32_bf16 v[116:119], v[176:179], v[184:187], v[116:119]
    ds_read_b64_tr_b16 v[176:177], v36 offset:38912
    ds_read_b64_tr_b16 v[178:179], v36 offset:39808
    s_waitcnt lgkmcnt(10)
    v_mfma_f32_16x16x32_bf16 v[64:67], v[156:159], v[180:183], v[64:67]
    v_mfma_f32_16x16x32_bf16 v[68:71], v[156:159], v[184:187], v[68:71]
    s_add_u32 s59, s61, 9088
    s_add_u32 m0, s62, 46080
    s_nop 0
    buffer_load_dwordx4 v16, s[36:39], s59 offen lds
    ds_read_b64_tr_b16 v[156:157], v37 offset:24576
    ds_read_b64_tr_b16 v[158:159], v37 offset:25472
    s_waitcnt lgkmcnt(10)
    v_mfma_f32_16x16x32_bf16 v[120:123], v[160:163], v[180:183], v[120:123]
    v_mfma_f32_16x16x32_bf16 v[124:127], v[160:163], v[184:187], v[124:127]
    ds_read_b64_tr_b16 v[160:161], v37 offset:38912
    ds_read_b64_tr_b16 v[162:163], v37 offset:39808
    s_waitcnt lgkmcnt(10)
    v_mfma_f32_16x16x32_bf16 v[72:75], v[164:167], v[180:183], v[72:75]
    v_mfma_f32_16x16x32_bf16 v[76:79], v[164:167], v[184:187], v[76:79]
    s_add_u32 m0, s57, 47104
    s_nop 0
    buffer_load_dwordx4 v7, s[48:51], s58 offen lds
    ds_read_b64_tr_b16 v[164:165], v31 offset:31744
    ds_read_b64_tr_b16 v[166:167], v31 offset:32640
    s_waitcnt lgkmcnt(10)
    v_mfma_f32_16x16x32_bf16 v[128:131], v[168:171], v[180:183], v[128:131]
    v_mfma_f32_16x16x32_bf16 v[132:135], v[168:171], v[184:187], v[132:135]
    ds_read_b64_tr_b16 v[168:169], v31 offset:46080
    ds_read_b64_tr_b16 v[170:171], v31 offset:46976
    s_waitcnt lgkmcnt(10)
    v_mfma_f32_16x16x32_bf16 v[80:83], v[172:175], v[180:183], v[80:83]
    v_mfma_f32_16x16x32_bf16 v[84:87], v[172:175], v[184:187], v[84:87]
    s_add_u32 s59, s61, 17280
    s_add_u32 m0, s62, 47104
    s_nop 0
    buffer_load_dwordx4 v16, s[36:39], s59 offen lds
    ds_read_b64_tr_b16 v[172:173], v32 offset:31744
    ds_read_b64_tr_b16 v[174:175], v32 offset:32640
    s_waitcnt lgkmcnt(10)
    v_mfma_f32_16x16x32_bf16 v[136:139], v[176:179], v[180:183], v[136:139]
    v_mfma_f32_16x16x32_bf16 v[140:143], v[176:179], v[184:187], v[140:143]
    ds_read_b64_tr_b16 v[176:177], v32 offset:46080
    ds_read_b64_tr_b16 v[178:179], v32 offset:46976
    s_waitcnt lgkmcnt(10)
    v_mfma_f32_16x16x32_bf16 v[88:91], v[156:159], v[180:183], v[88:91]
    v_mfma_f32_16x16x32_bf16 v[92:95], v[156:159], v[184:187], v[92:95]
    s_add_u32 m0, s57, 48128
    s_nop 0
    buffer_load_dwordx4 v8, s[48:51], s58 offen lds
    ds_read_b64_tr_b16 v[156:157], v33 offset:31744
    ds_read_b64_tr_b16 v[158:159], v33 offset:32640
    s_waitcnt lgkmcnt(10)
    v_mfma_f32_16x16x32_bf16 v[144:147], v[160:163], v[180:183], v[144:147]
    v_mfma_f32_16x16x32_bf16 v[148:151], v[160:163], v[184:187], v[148:151]
    ds_read_b64_tr_b16 v[160:161], v33 offset:46080
    ds_read_b64_tr_b16 v[162:163], v33 offset:46976
    s_waitcnt lgkmcnt(10)
    v_mfma_f32_16x16x32_bf16 v[40:43], v[164:167], v[188:191], v[40:43]
    v_mfma_f32_16x16x32_bf16 v[44:47], v[164:167], v[192:195], v[44:47]
    s_add_u32 s59, s61, 25472
    s_add_u32 m0, s62, 48128
    s_nop 0
    buffer_load_dwordx4 v16, s[36:39], s59 offen lds
    ds_read_b64_tr_b16 v[164:165], v34 offset:31744
    ds_read_b64_tr_b16 v[166:167], v34 offset:32640
    s_waitcnt lgkmcnt(10)
    v_mfma_f32_16x16x32_bf16 v[96:99], v[168:171], v[188:191], v[96:99]
    v_mfma_f32_16x16x32_bf16 v[100:103], v[168:171], v[192:195], v[100:103]
    ds_read_b64_tr_b16 v[168:169], v34 offset:46080
    ds_read_b64_tr_b16 v[170:171], v34 offset:46976
    s_waitcnt lgkmcnt(10)
    v_mfma_f32_16x16x32_bf16 v[48:51], v[172:175], v[188:191], v[48:51]
    v_mfma_f32_16x16x32_bf16 v[52:55], v[172:175], v[192:195], v[52:55]
    s_add_u32 m0, s57, 49152
    s_nop 0
    buffer_load_dwordx4 v9, s[48:51], s58 offen lds
    ds_read_b64_tr_b16 v[172:173], v35 offset:31744
    ds_read_b64_tr_b16 v[174:175], v35 offset:32640
    s_waitcnt lgkmcnt(10)
    v_mfma_f32_16x16x32_bf16 v[104:107], v[176:179], v[188:191], v[104:107]
    v_mfma_f32_16x16x32_bf16 v[108:111], v[176:179], v[192:195], v[108:111]
    ds_read_b64_tr_b16 v[176:177], v35 offset:46080
    ds_read_b64_tr_b16 v[178:179], v35 offset:46976
    s_waitcnt lgkmcnt(10)
    v_mfma_f32_16x16x32_bf16 v[56:59], v[156:159], v[188:191], v[56:59]
    v_mfma_f32_16x16x32_bf16 v[60:63], v[156:159], v[192:195], v[60:63]
    s_add_u32 m0, s57, 50176
    s_nop 0
    buffer_load_dwordx4 v10, s[48:51], s58 offen lds
    ds_read_b64_tr_b16 v[156:157], v36 offset:31744
    ds_read_b64_tr_b16 v[158:159], v36 offset:32640
    s_waitcnt lgkmcnt(10)
    v_mfma_f32_16x16x32_bf16 v[112:115], v[160:163], v[188:191], v[112:115]
    v_mfma_f32_16x16x32_bf16 v[116:119], v[160:163], v[192:195], v[116:119]
    ds_read_b64_tr_b16 v[160:161], v36 offset:46080
    ds_read_b64_tr_b16 v[162:163], v36 offset:46976
    s_waitcnt lgkmcnt(10)
    v_mfma_f32_16x16x32_bf16 v[64:67], v[164:167], v[188:191], v[64:67]
    v_mfma_f32_16x16x32_bf16 v[68:71], v[164:167], v[192:195], v[68:71]
    s_add_u32 m0, s57, 51200
    s_nop 0
    buffer_load_dwordx4 v11, s[48:51], s58 offen lds
    ds_read_b64_tr_b16 v[164:165], v37 offset:31744
    ds_read_b64_tr_b16 v[166:167], v37 offset:32640
    s_waitcnt lgkmcnt(10)
    v_mfma_f32_16x16x32_bf16 v[120:123], v[168:171], v[188:191], v[120:123]
    v_mfma_f32_16x16x32_bf16 v[124:127], v[168:171], v[192:195], v[124:127]
    ds_read_b64_tr_b16 v[168:169], v37 offset:46080
    ds_read_b64_tr_b16 v[170:171], v37 offset:46976
    s_waitcnt lgkmcnt(10)
    v_mfma_f32_16x16x32_bf16 v[72:75], v[172:175], v[188:191], v[72:75]
    v_mfma_f32_16x16x32_bf16 v[76:79], v[172:175], v[192:195], v[76:79]
    s_waitcnt lgkmcnt(8)
    v_mfma_f32_16x16x32_bf16 v[128:131], v[176:179], v[188:191], v[128:131]
    v_mfma_f32_16x16x32_bf16 v[132:135], v[176:179], v[192:195], v[132:135]
    s_waitcnt lgkmcnt(6)
    v_mfma_f32_16x16x32_bf16 v[80:83], v[156:159], v[188:191], v[80:83]
    v_mfma_f32_16x16x32_bf16 v[84:87], v[156:159], v[192:195], v[84:87]
    s_waitcnt lgkmcnt(4)
    v_mfma_f32_16x16x32_bf16 v[136:139], v[160:163], v[188:191], v[136:139]
    v_mfma_f32_16x16x32_bf16 v[140:143], v[160:163], v[192:195], v[140:143]
    s_waitcnt lgkmcnt(2)
    v_mfma_f32_16x16x32_bf16 v[88:91], v[164:167], v[188:191], v[88:91]
    v_mfma_f32_16x16x32_bf16 v[92:95], v[164:167], v[192:195], v[92:95]
    s_waitcnt lgkmcnt(0)
    v_mfma_f32_16x16x32_bf16 v[144:147], v[168:171], v[188:191], v[144:147]
    v_mfma_f32_16x16x32_bf16 v[148:151], v[168:171], v[192:195], v[148:151]
    s_waitcnt vmcnt(11)
    s_mov_b64 exec, 1
    ds_add_u32 v152, v153
    s_mov_b64 exec, -1
    s_nop 3
GSPIN_6:
    ds_read_b32 v154, v152
    s_waitcnt lgkmcnt(0)
    v_readfirstlane_b32 s63, v154
    s_cmp_lt_u32 s63, 24
    s_cbranch_scc1 GSPIN_6
    ds_read_b128 v[180:183], v17 offset:0
    ds_read_b128 v[184:187], v17 offset:2048
    ds_read_b128 v[188:191], v18 offset:0
    ds_read_b128 v[192:195], v18 offset:2048
    ds_read_b64_tr_b16 v[156:157], v23 offset:0
    ds_read_b64_tr_b16 v[158:159], v23 offset:896
    ds_read_b64_tr_b16 v[160:161], v23 offset:14336
    ds_read_b64_tr_b16 v[162:163], v23 offset:15232
    ds_read_b64_tr_b16 v[164:165], v24 offset:0
    ds_read_b64_tr_b16 v[166:167], v24 offset:896
    ds_read_b64_tr_b16 v[168:169], v24 offset:14336
    ds_read_b64_tr_b16 v[170:171], v24 offset:15232
    ds_read_b64_tr_b16 v[172:173], v25 offset:0
    ds_read_b64_tr_b16 v[174:175], v25 offset:896
    ds_read_b64_tr_b16 v[176:177], v25 offset:14336
    ds_read_b64_tr_b16 v[178:179], v25 offset:15232
    s_waitcnt lgkmcnt(10)
    v_mfma_f32_16x16x32_bf16 v[40:43], v[156:159], v[180:183], v[40:43]
    v_mfma_f32_16x16x32_bf16 v[44:47], v[156:159], v[184:187], v[44:47]
    ds_read_b64_tr_b16 v[156:157], v26 offset:0
    ds_read_b64_tr_b16 v[158:159], v26 offset:896
    s_waitcnt lgkmcnt(10)
    v_mfma_f32_16x16x32_bf16 v[96:99], v[160:163], v[180:183], v[96:99]
    v_mfma_f32_16x16x32_bf16 v[100:103], v[160:163], v[184:187], v[100:103]
    ds_read_b64_tr_b16 v[160:161], v26 offset:14336
    ds_read_b64_tr_b16 v[162:163], v26 offset:15232
    s_waitcnt lgkmcnt(10)
    v_mfma_f32_16x16x32_bf16 v[48:51], v[164:167], v[180:183], v[48:51]
    v_mfma_f32_16x16x32_bf16 v[52:55], v[164:167], v[184:187], v[52:55]
    ds_read_b64_tr_b16 v[164:165], v27 offset:0
    ds_read_b64_tr_b16 v[166:167], v27 offset:896
    s_waitcnt lgkmcnt(10)
    v_mfma_f32_16x16x32_bf16 v[104:107], v[168:171], v[180:183], v[104:107]
    v_mfma_f32_16x16x32_bf16 v[108:111], v[168:171], v[184:187], v[108:111]
    ds_read_b64_tr_b16 v[168:169], v27 offset:14336
    ds_read_b64_tr_b16 v[170:171], v27 offset:15232
    s_waitcnt lgkmcnt(10)
    v_mfma_f32_16x16x32_bf16 v[56:59], v[172:175], v[180:183], v[56:59]
    v_mfma_f32_16x16x32_bf16 v[60:63], v[172:175], v[184:187], v[60:63]
    ds_read_b64_tr_b16 v[172:173], v28 offset:0
    ds_read_b64_tr_b16 v[174:175], v28 offset:896
    s_waitcnt lgkmcnt(10)
    v_mfma_f32_16x16x32_bf16 v[112:115], v[176:179], v[180:183], v[112:115]
    v_mfma_f32_16x16x32_bf16 v[116:119], v[176:179], v[184:187], v[116:119]
    ds_read_b64_tr_b16 v[176:177], v28 offset:14336
    ds_read_b64_tr_b16 v[178:179], v28 offset:15232
    s_waitcnt lgkmcnt(10)
    v_mfma_f32_16x16x32_bf16 v[64:67], v[156:159], v[180:183], v[64:67]
    v_mfma_f32_16x16x32_bf16 v[68:71], v[156:159], v[184:187], v[68:71]
    ds_read_b64_tr_b16 v[156:157], v29 offset:0
    ds_read_b64_tr_b16 v[158:159], v29 offset:896
    s_waitcnt lgkmcnt(10)
    v_mfma_f32_16x16x32_bf16 v[120:123], v[160:163], v[180:183], v[120:123]
    v_mfma_f32_16x16x32_bf16 v[124:127], v[160:163], v[184:187], v[124:127]
    ds_read_b64_tr_b16 v[160:161], v29 offset:14336
    ds_read_b64_tr_b16 v[162:163], v29 offset:15232
    s_waitcnt lgkmcnt(10)
    v_mfma_f32_16x16x32_bf16 v[72:75], v[164:167], v[180:183], v[72:75]
    v_mfma_f32_16x16x32_bf16 v[76:79], v[164:167], v[184:187], v[76:79]
    ds_read_b64_tr_b16 v[164:165], v23 offset:7168
    ds_read_b64_tr_b16 v[166:167], v23 offset:8064
    s_waitcnt lgkmcnt(10)
    v_mfma_f32_16x16x32_bf16 v[128:131], v[168:171], v[180:183], v[128:131]
    v_mfma_f32_16x16x32_bf16 v[132:135], v[168:171], v[184:187], v[132:135]
    ds_read_b64_tr_b16 v[168:169], v23 offset:21504
    ds_read_b64_tr_b16 v[170:171], v23 offset:22400
    s_waitcnt lgkmcnt(10)
    v_mfma_f32_16x16x32_bf16 v[80:83], v[172:175], v[180:183], v[80:83]
    v_mfma_f32_16x16x32_bf16 v[84:87], v[172:175], v[184:187], v[84:87]
    ds_read_b64_tr_b16 v[172:173], v24 offset:7168
    ds_read_b64_tr_b16 v[174:175], v24 offset:8064
    s_waitcnt lgkmcnt(10)
    v_mfma_f32_16x16x32_bf16 v[136:139], v[176:179], v[180:183], v[136:139]
    v_mfma_f32_16x16x32_bf16 v[140:143], v[176:179], v[184:187], v[140:143]
    ds_read_b64_tr_b16 v[176:177], v24 offset:21504
    ds_read_b64_tr_b16 v[178:179], v24 offset:22400
    s_waitcnt lgkmcnt(10)
    v_mfma_f32_16x16x32_bf16 v[88:91], v[156:159], v[180:183], v[88:91]
    v_mfma_f32_16x16x32_bf16 v[92:95], v[156:159], v[184:187], v[92:95]
    ds_read_b64_tr_b16 v[156:157], v25 offset:7168
    ds_read_b64_tr_b16 v[158:159], v25 offset:8064
    s_waitcnt lgkmcnt(10)
    v_mfma_f32_16x16x32_bf16 v[144:147], v[160:163], v[180:183], v[144:147]
    v_mfma_f32_16x16x32_bf16 v[148:151], v[160:163], v[184:187], v[148:151]
    ds_read_b64_tr_b16 v[160:161], v25 offset:21504
    ds_read_b64_tr_b16 v[162:163], v25 offset:22400
    s_waitcnt lgkmcnt(10)
    v_mfma_f32_16x16x32_bf16 v[40:43], v[164:167], v[188:191], v[40:43]
    v_mfma_f32_16x16x32_bf16 v[44:47], v[164:167], v[192:195], v[44:47]
    ds_read_b64_tr_b16 v[164:165], v26 offset:7168
    ds_read_b64_tr_b16 v[166:167], v26 offset:8064
    s_waitcnt lgkmcnt(10)
    v_mfma_f32_16x16x32_bf16 v[96:99], v[168:171], v[188:191], v[96:99]
    v_mfma_f32_16x16x32_bf16 v[100:103], v[168:171], v[192:195], v[100:103]
    ds_read_b64_tr_b16 v[168:169], v26 offset:21504
    ds_read_b64_tr_b16 v[170:171], v26 offset:22400
    s_waitcnt lgkmcnt(10)
    v_mfma_f32_16x16x32_bf16 v[48:51], v[172:175], v[188:191], v[48:51]
    v_mfma_f32_16x16x32_bf16 v[52:55], v[172:175], v[192:195], v[52:55]
    ds_read_b64_tr_b16 v[172:173], v27 offset:7168
    ds_read_b64_tr_b16 v[174:175], v27 offset:8064
    s_waitcnt lgkmcnt(10)
    v_mfma_f32_16x16x32_bf16 v[104:107], v[176:179], v[188:191], v[104:107]
    v_mfma_f32_16x16x32_bf16 v[108:111], v[176:179], v[192:195], v[108:111]
    ds_read_b64_tr_b16 v[176:177], v27 offset:21504
    ds_read_b64_tr_b16 v[178:179], v27 offset:22400
    s_waitcnt lgkmcnt(10)
    v_mfma_f32_16x16x32_bf16 v[56:59], v[156:159], v[188:191], v[56:59]
    v_mfma_f32_16x16x32_bf16 v[60:63], v[156:159], v[192:195], v[60:63]
    ds_read_b64_tr_b16 v[156:157], v28 offset:7168
    ds_read_b64_tr_b16 v[158:159], v28 offset:8064
    s_waitcnt lgkmcnt(10)
    v_mfma_f32_16x16x32_bf16 v[112:115], v[160:163], v[188:191], v[112:115]
    v_mfma_f32_16x16x32_bf16 v[116:119], v[160:163], v[192:195], v[116:119]
    ds_read_b64_tr_b16 v[160:161], v28 offset:21504
    ds_read_b64_tr_b16 v[162:163], v28 offset:22400
    s_waitcnt lgkmcnt(10)
    v_mfma_f32_16x16x32_bf16 v[64:67], v[164:167], v[188:191], v[64:67]
    v_mfma_f32_16x16x32_bf16 v[68:71], v[164:167], v[192:195], v[68:71]
    ds_read_b64_tr_b16 v[164:165], v29 offset:7168
    ds_read_b64_tr_b16 v[166:167], v29 offset:8064
    s_waitcnt lgkmcnt(10)
    v_mfma_f32_16x16x32_bf16 v[120:123], v[168:171], v[188:191], v[120:123]
    v_mfma_f32_16x16x32_bf16 v[124:127], v[168:171], v[192:195], v[124:127]
    ds_read_b64_tr_b16 v[168:169], v29 offset:21504
    ds_read_b64_tr_b16 v[170:171], v29 offset:22400
    s_waitcnt lgkmcnt(10)
    v_mfma_f32_16x16x32_bf16 v[72:75], v[172:175], v[188:191], v[72:75]
    v_mfma_f32_16x16x32_bf16 v[76:79], v[172:175], v[192:195], v[76:79]
    s_waitcnt lgkmcnt(8)
    v_mfma_f32_16x16x32_bf16 v[128:131], v[176:179], v[188:191], v[128:131]
    v_mfma_f32_16x16x32_bf16 v[132:135], v[176:179], v[192:195], v[132:135]
    s_waitcnt lgkmcnt(6)
    v_mfma_f32_16x16x32_bf16 v[80:83], v[156:159], v[188:191], v[80:83]
    v_mfma_f32_16x16x32_bf16 v[84:87], v[156:159], v[192:195], v[84:87]
    s_waitcnt lgkmcnt(4)
    v_mfma_f32_16x16x32_bf16 v[136:139], v[160:163], v[188:191], v[136:139]
    v_mfma_f32_16x16x32_bf16 v[140:143], v[160:163], v[192:195], v[140:143]
    s_waitcnt lgkmcnt(2)
    v_mfma_f32_16x16x32_bf16 v[88:91], v[164:167], v[188:191], v[88:91]
    v_mfma_f32_16x16x32_bf16 v[92:95], v[164:167], v[192:195], v[92:95]
    s_waitcnt lgkmcnt(0)
    v_mfma_f32_16x16x32_bf16 v[144:147], v[168:171], v[188:191], v[144:147]
    v_mfma_f32_16x16x32_bf16 v[148:151], v[168:171], v[192:195], v[148:151]
    s_waitcnt vmcnt(0)
    s_mov_b64 exec, 1
    ds_add_u32 v152, v153
    s_mov_b64 exec, -1
    s_nop 3
GSPIN_7:
    ds_read_b32 v154, v152
    s_waitcnt lgkmcnt(0)
    v_readfirstlane_b32 s63, v154
    s_cmp_lt_u32 s63, 28
    s_cbranch_scc1 GSPIN_7
    ds_read_b128 v[180:183], v17 offset:45056
    ds_read_b128 v[184:187], v17 offset:47104
    ds_read_b128 v[188:191], v18 offset:45056
    ds_read_b128 v[192:195], v18 offset:47104
    ds_read_b64_tr_b16 v[156:157], v23 offset:45056
    ds_read_b64_tr_b16 v[158:159], v23 offset:45952
    ds_read_b64_tr_b16 v[160:161], v23 offset:59392
    ds_read_b64_tr_b16 v[162:163], v23 offset:60288
    ds_read_b64_tr_b16 v[164:165], v24 offset:45056
    ds_read_b64_tr_b16 v[166:167], v24 offset:45952
    ds_read_b64_tr_b16 v[168:169], v24 offset:59392
    ds_read_b64_tr_b16 v[170:171], v24 offset:60288
    ds_read_b64_tr_b16 v[172:173], v25 offset:45056
    ds_read_b64_tr_b16 v[174:175], v25 offset:45952
    ds_read_b64_tr_b16 v[176:177], v25 offset:59392
    ds_read_b64_tr_b16 v[178:179], v25 offset:60288
    s_waitcnt lgkmcnt(10)
    v_mfma_f32_16x16x32_bf16 v[40:43], v[156:159], v[180:183], v[40:43]
    v_mfma_f32_16x16x32_bf16 v[44:47], v[156:159], v[184:187], v[44:47]
    ds_read_b64_tr_b16 v[156:157], v26 offset:45056
    ds_read_b64_tr_b16 v[158:159], v26 offset:45952
    s_waitcnt lgkmcnt(10)
    v_mfma_f32_16x16x32_bf16 v[96:99], v[160:163], v[180:183], v[96:99]
    v_mfma_f32_16x16x32_bf16 v[100:103], v[160:163], v[184:187], v[100:103]
    ds_read_b64_tr_b16 v[160:161], v26 offset:59392
    ds_read_b64_tr_b16 v[162:163], v26 offset:60288
    s_waitcnt lgkmcnt(10)
    v_mfma_f32_16x16x32_bf16 v[48:51], v[164:167], v[180:183], v[48:51]
    v_mfma_f32_16x16x32_bf16 v[52:55], v[164:167], v[184:187], v[52:55]
    ds_read_b64_tr_b16 v[164:165], v27 offset:45056
    ds_read_b64_tr_b16 v[166:167], v27 offset:45952
    s_waitcnt lgkmcnt(10)
    v_mfma_f32_16x16x32_bf16 v[104:107], v[168:171], v[180:183], v[104:107]
    v_mfma_f32_16x16x32_bf16 v[108:111], v[168:171], v[184:187], v[108:111]
    ds_read_b64_tr_b16 v[168:169], v27 offset:59392
    ds_read_b64_tr_b16 v[170:171], v27 offset:60288
    s_waitcnt lgkmcnt(10)
    v_mfma_f32_16x16x32_bf16 v[56:59], v[172:175], v[180:183], v[56:59]
    v_mfma_f32_16x16x32_bf16 v[60:63], v[172:175], v[184:187], v[60:63]
    ds_read_b64_tr_b16 v[172:173], v28 offset:45056
    ds_read_b64_tr_b16 v[174:175], v28 offset:45952
    s_waitcnt lgkmcnt(10)
    v_mfma_f32_16x16x32_bf16 v[112:115], v[176:179], v[180:183], v[112:115]
    v_mfma_f32_16x16x32_bf16 v[116:119], v[176:179], v[184:187], v[116:119]
    ds_read_b64_tr_b16 v[176:177], v28 offset:59392
    ds_read_b64_tr_b16 v[178:179], v28 offset:60288
    s_waitcnt lgkmcnt(10)
    v_mfma_f32_16x16x32_bf16 v[64:67], v[156:159], v[180:183], v[64:67]
    v_mfma_f32_16x16x32_bf16 v[68:71], v[156:159], v[184:187], v[68:71]
    ds_read_b64_tr_b16 v[156:157], v29 offset:45056
    ds_read_b64_tr_b16 v[158:159], v29 offset:45952
    s_waitcnt lgkmcnt(10)
    v_mfma_f32_16x16x32_bf16 v[120:123], v[160:163], v[180:183], v[120:123]
    v_mfma_f32_16x16x32_bf16 v[124:127], v[160:163], v[184:187], v[124:127]
    ds_read_b64_tr_b16 v[160:161], v29 offset:59392
    ds_read_b64_tr_b16 v[162:163], v29 offset:60288
    s_waitcnt lgkmcnt(10)
    v_mfma_f32_16x16x32_bf16 v[72:75], v[164:167], v[180:183], v[72:75]
    v_mfma_f32_16x16x32_bf16 v[76:79], v[164:167], v[184:187], v[76:79]
    ds_read_b64_tr_b16 v[164:165], v23 offset:52224
    ds_read_b64_tr_b16 v[166:167], v23 offset:53120
    s_waitcnt lgkmcnt(10)
    v_mfma_f32_16x16x32_bf16 v[128:131], v[168:171], v[180:183], v[128:131]
    v_mfma_f32_16x16x32_bf16 v[132:135], v[168:171], v[184:187], v[132:135]
    ds_read_b64_tr_b16 v[168:169], v31 offset:1024
    ds_read_b64_tr_b16 v[170:171], v31 offset:1920
    s_waitcnt lgkmcnt(10)
    v_mfma_f32_16x16x32_bf16 v[80:83], v[172:175], v[180:183], v[80:83]
    v_mfma_f32_16x16x32_bf16 v[84:87], v[172:175], v[184:187], v[84:87]
    ds_read_b64_tr_b16 v[172:173], v24 offset:52224
    ds_read_b64_tr_b16 v[174:175], v24 offset:53120
    s_waitcnt lgkmcnt(10)
    v_mfma_f32_16x16x32_bf16 v[136:139], v[176:179], v[180:183], v[136:139]
    v_mfma_f32_16x16x32_bf16 v[140:143], v[176:179], v[184:187], v[140:143]
    ds_read_b64_tr_b16 v[176:177], v32 offset:1024
    ds_read_b64_tr_b16 v[178:179], v32 offset:1920
    s_waitcnt lgkmcnt(10)
    v_mfma_f32_16x16x32_bf16 v[88:91], v[156:159], v[180:183], v[88:91]
    v_mfma_f32_16x16x32_bf16 v[92:95], v[156:159], v[184:187], v[92:95]
    ds_read_b64_tr_b16 v[156:157], v25 offset:52224
    ds_read_b64_tr_b16 v[158:159], v25 offset:53120
    s_waitcnt lgkmcnt(10)
    v_mfma_f32_16x16x32_bf16 v[144:147], v[160:163], v[180:183], v[144:147]
    v_mfma_f32_16x16x32_bf16 v[148:151], v[160:163], v[184:187], v[148:151]
    ds_read_b64_tr_b16 v[160:161], v33 offset:1024
    ds_read_b64_tr_b16 v[162:163], v33 offset:1920
    s_waitcnt lgkmcnt(10)
    v_mfma_f32_16x16x32_bf16 v[40:43], v[164:167], v[188:191], v[40:43]
    v_mfma_f32_16x16x32_bf16 v[44:47], v[164:167], v[192:195], v[44:47]
    ds_read_b64_tr_b16 v[164:165], v26 offset:52224
    ds_read_b64_tr_b16 v[166:167], v26 offset:53120
    s_waitcnt lgkmcnt(10)
    v_mfma_f32_16x16x32_bf16 v[96:99], v[168:171], v[188:191], v[96:99]
    v_mfma_f32_16x16x32_bf16 v[100:103], v[168:171], v[192:195], v[100:103]
    ds_read_b64_tr_b16 v[168:169], v34 offset:1024
    ds_read_b64_tr_b16 v[170:171], v34 offset:1920
    s_waitcnt lgkmcnt(10)
    v_mfma_f32_16x16x32_bf16 v[48:51], v[172:175], v[188:191], v[48:51]
    v_mfma_f32_16x16x32_bf16 v[52:55], v[172:175], v[192:195], v[52:55]
    ds_read_b64_tr_b16 v[172:173], v27 offset:52224
    ds_read_b64_tr_b16 v[174:175], v27 offset:53120
    s_waitcnt lgkmcnt(10)
    v_mfma_f32_16x16x32_bf16 v[104:107], v[176:179], v[188:191], v[104:107]
    v_mfma_f32_16x16x32_bf16 v[108:111], v[176:179], v[192:195], v[108:111]
    ds_read_b64_tr_b16 v[176:177], v35 offset:1024
    ds_read_b64_tr_b16 v[178:179], v35 offset:1920
    s_waitcnt lgkmcnt(10)
    v_mfma_f32_16x16x32_bf16 v[56:59], v[156:159], v[188:191], v[56:59]
    v_mfma_f32_16x16x32_bf16 v[60:63], v[156:159], v[192:195], v[60:63]
    ds_read_b64_tr_b16 v[156:157], v28 offset:52224
    ds_read_b64_tr_b16 v[158:159], v28 offset:53120
    s_waitcnt lgkmcnt(10)
    v_mfma_f32_16x16x32_bf16 v[112:115], v[160:163], v[188:191], v[112:115]
    v_mfma_f32_16x16x32_bf16 v[116:119], v[160:163], v[192:195], v[116:119]
    ds_read_b64_tr_b16 v[160:161], v36 offset:1024
    ds_read_b64_tr_b16 v[162:163], v36 offset:1920
    s_waitcnt lgkmcnt(10)
    v_mfma_f32_16x16x32_bf16 v[64:67], v[164:167], v[188:191], v[64:67]
    v_mfma_f32_16x16x32_bf16 v[68:71], v[164:167], v[192:195], v[68:71]
    ds_read_b64_tr_b16 v[164:165], v29 offset:52224
    ds_read_b64_tr_b16 v[166:167], v29 offset:53120
    s_waitcnt lgkmcnt(10)
    v_mfma_f32_16x16x32_bf16 v[120:123], v[168:171], v[188:191], v[120:123]
    v_mfma_f32_16x16x32_bf16 v[124:127], v[168:171], v[192:195], v[124:127]
    ds_read_b64_tr_b16 v[168:169], v37 offset:1024
    ds_read_b64_tr_b16 v[170:171], v37 offset:1920
    s_waitcnt lgkmcnt(10)
    v_mfma_f32_16x16x32_bf16 v[72:75], v[172:175], v[188:191], v[72:75]
    v_mfma_f32_16x16x32_bf16 v[76:79], v[172:175], v[192:195], v[76:79]
    s_waitcnt lgkmcnt(8)
    v_mfma_f32_16x16x32_bf16 v[128:131], v[176:179], v[188:191], v[128:131]
    v_mfma_f32_16x16x32_bf16 v[132:135], v[176:179], v[192:195], v[132:135]
    s_waitcnt lgkmcnt(6)
    v_mfma_f32_16x16x32_bf16 v[80:83], v[156:159], v[188:191], v[80:83]
    v_mfma_f32_16x16x32_bf16 v[84:87], v[156:159], v[192:195], v[84:87]
    s_waitcnt lgkmcnt(4)
    v_mfma_f32_16x16x32_bf16 v[136:139], v[160:163], v[188:191], v[136:139]
    v_mfma_f32_16x16x32_bf16 v[140:143], v[160:163], v[192:195], v[140:143]
    s_waitcnt lgkmcnt(2)
    v_mfma_f32_16x16x32_bf16 v[88:91], v[164:167], v[188:191], v[88:91]
    v_mfma_f32_16x16x32_bf16 v[92:95], v[164:167], v[192:195], v[92:95]
    s_waitcnt lgkmcnt(0)
    v_mfma_f32_16x16x32_bf16 v[144:147], v[168:171], v[188:191], v[144:147]
    v_mfma_f32_16x16x32_bf16 v[148:151], v[168:171], v[192:195], v[148:151]
    s_mov_b64 exec, 1
    ds_add_u32 v152, v153
    s_mov_b64 exec, -1
    s_setprio 0
    s_mov_b32 s64, 0xffff0000
    s_mov_b32 s66, 0xc0135761
    s_mov_b32 s68, 0xbdd2d3e8
    s_mov_b32 s67, 0xc0135761
    s_mov_b32 s69, 0xbdd2d3e8
    v_cvt_pk_bf16_f32 v197, v40, v41
    v_cvt_pk_bf16_f32 v205, v96, v97
    v_cvt_pk_bf16_f32 v199, v42, v43
    v_cvt_pk_bf16_f32 v207, v98, v99
    v_lshlrev_b32 v196, 16, v197
    v_and_b32 v197, s64, v197
    v_lshlrev_b32 v198, 16, v199
    v_and_b32 v199, s64, v199
    v_pk_mul_f32 v[212:213], v[196:197], v[196:197]
    v_pk_mul_f32 v[214:215], v[198:199], v[198:199]
    v_pk_mul_f32 v[212:213], v[212:213], s[68:69]
    v_pk_mul_f32 v[214:215], v[214:215], s[68:69]
    v_pk_add_f32 v[212:213], v[212:213], s[66:67]
    v_pk_add_f32 v[214:215], v[214:215], s[66:67]
    v_pk_mul_f32 v[212:213], v[212:213], v[196:197]
    v_pk_mul_f32 v[214:215], v[214:215], v[198:199]
    v_exp_f32 v212, v212
    v_exp_f32 v213, v213
    v_exp_f32 v214, v214
    v_exp_f32 v215, v215
    v_lshlrev_b32 v204, 16, v205
    v_and_b32 v205, s64, v205
    v_lshlrev_b32 v206, 16, v207
    v_and_b32 v207, s64, v207
    v_pk_add_f32 v[212:213], v[212:213], 1.0 op_sel_hi:[1,0]
    v_pk_add_f32 v[214:215], v[214:215], 1.0 op_sel_hi:[1,0]
    v_rcp_f32 v212, v212
    v_rcp_f32 v213, v213
    v_rcp_f32 v214, v214
    v_rcp_f32 v215, v215
    v_pk_mul_f32 v[212:213], v[212:213], v[196:197]
    v_pk_mul_f32 v[214:215], v[214:215], v[198:199]
    v_cvt_pk_bf16_f32 v213, v212, v213
    v_cvt_pk_bf16_f32 v215, v214, v215
    v_lshlrev_b32 v212, 16, v213
    v_and_b32 v213, s64, v213
    v_lshlrev_b32 v214, 16, v215
    v_and_b32 v215, s64, v215
    v_pk_mul_f32 v[212:213], v[212:213], v[204:205]
    v_pk_mul_f32 v[214:215], v[214:215], v[206:207]
    v_cvt_pk_bf16_f32 v220, v212, v213
    v_cvt_pk_bf16_f32 v221, v214, v215
    buffer_store_dwordx2 v[220:221], v21, s[40:43], 0 offen offset:0
    v_cvt_pk_bf16_f32 v201, v48, v49
    v_cvt_pk_bf16_f32 v209, v104, v105
    v_cvt_pk_bf16_f32 v203, v50, v51
    v_cvt_pk_bf16_f32 v211, v106, v107
    v_lshlrev_b32 v200, 16, v201
    v_and_b32 v201, s64, v201
    v_lshlrev_b32 v202, 16, v203
    v_and_b32 v203, s64, v203
    v_pk_mul_f32 v[216:217], v[200:201], v[200:201]
    v_pk_mul_f32 v[218:219], v[202:203], v[202:203]
    v_pk_mul_f32 v[216:217], v[216:217], s[68:69]
    v_pk_mul_f32 v[218:219], v[218:219], s[68:69]
    v_pk_add_f32 v[216:217], v[216:217], s[66:67]
    v_pk_add_f32 v[218:219], v[218:219], s[66:67]
    v_pk_mul_f32 v[216:217], v[216:217], v[200:201]
    v_pk_mul_f32 v[218:219], v[218:219], v[202:203]
    v_exp_f32 v216, v216
    v_exp_f32 v217, v217
    v_exp_f32 v218, v218
    v_exp_f32 v219, v219
    v_lshlrev_b32 v208, 16, v209
    v_and_b32 v209, s64, v209
    v_lshlrev_b32 v210, 16, v211
    v_and_b32 v211, s64, v211
    v_pk_add_f32 v[216:217], v[216:217], 1.0 op_sel_hi:[1,0]
    v_pk_add_f32 v[218:219], v[218:219], 1.0 op_sel_hi:[1,0]
    v_rcp_f32 v216, v216
    v_rcp_f32 v217, v217
    v_rcp_f32 v218, v218
    v_rcp_f32 v219, v219
    v_pk_mul_f32 v[216:217], v[216:217], v[200:201]
    v_pk_mul_f32 v[218:219], v[218:219], v[202:203]
    v_cvt_pk_bf16_f32 v217, v216, v217
    v_cvt_pk_bf16_f32 v219, v218, v219
    v_lshlrev_b32 v216, 16, v217
    v_and_b32 v217, s64, v217
    v_lshlrev_b32 v218, 16, v219
    v_and_b32 v219, s64, v219
    v_pk_mul_f32 v[216:217], v[216:217], v[208:209]
    v_pk_mul_f32 v[218:219], v[218:219], v[210:211]
    v_cvt_pk_bf16_f32 v222, v216, v217
    v_cvt_pk_bf16_f32 v223, v218, v219
    buffer_store_dwordx2 v[222:223], v21, s[40:43], 0 offen offset:32
    v_cvt_pk_bf16_f32 v197, v56, v57
    v_cvt_pk_bf16_f32 v205, v112, v113
    v_cvt_pk_bf16_f32 v199, v58, v59
    v_cvt_pk_bf16_f32 v207, v114, v115
    v_lshlrev_b32 v196, 16, v197
    v_and_b32 v197, s64, v197
    v_lshlrev_b32 v198, 16, v199
    v_and_b32 v199, s64, v199
    v_pk_mul_f32 v[212:213], v[196:197], v[196:197]
    v_pk_mul_f32 v[214:215], v[198:199], v[198:199]
    v_pk_mul_f32 v[212:213], v[212:213], s[68:69]
    v_pk_mul_f32 v[214:215], v[214:215], s[68:69]
    v_pk_add_f32 v[212:213], v[212:213], s[66:67]
    v_pk_add_f32 v[214:215], v[214:215], s[66:67]
    v_pk_mul_f32 v[212:213], v[212:213], v[196:197]
    v_pk_mul_f32 v[214:215], v[214:215], v[198:199]
    v_exp_f32 v212, v212
    v_exp_f32 v213, v213
    v_exp_f32 v214, v214
    v_exp_f32 v215, v215
    v_lshlrev_b32 v204, 16, v205
    v_and_b32 v205, s64, v205
    v_lshlrev_b32 v206, 16, v207
    v_and_b32 v207, s64, v207
    v_pk_add_f32 v[212:213], v[212:213], 1.0 op_sel_hi:[1,0]
    v_pk_add_f32 v[214:215], v[214:215], 1.0 op_sel_hi:[1,0]
    v_rcp_f32 v212, v212
    v_rcp_f32 v213, v213
    v_rcp_f32 v214, v214
    v_rcp_f32 v215, v215
    v_pk_mul_f32 v[212:213], v[212:213], v[196:197]
    v_pk_mul_f32 v[214:215], v[214:215], v[198:199]
    v_cvt_pk_bf16_f32 v213, v212, v213
    v_cvt_pk_bf16_f32 v215, v214, v215
    v_lshlrev_b32 v212, 16, v213
    v_and_b32 v213, s64, v213
    v_lshlrev_b32 v214, 16, v215
    v_and_b32 v215, s64, v215
    v_pk_mul_f32 v[212:213], v[212:213], v[204:205]
    v_pk_mul_f32 v[214:215], v[214:215], v[206:207]
    v_cvt_pk_bf16_f32 v220, v212, v213
    v_cvt_pk_bf16_f32 v221, v214, v215
    buffer_store_dwordx2 v[220:221], v21, s[40:43], 0 offen offset:64
    v_cvt_pk_bf16_f32 v201, v64, v65
    v_cvt_pk_bf16_f32 v209, v120, v121
    v_cvt_pk_bf16_f32 v203, v66, v67
    v_cvt_pk_bf16_f32 v211, v122, v123
    v_lshlrev_b32 v200, 16, v201
    v_and_b32 v201, s64, v201
    v_lshlrev_b32 v202, 16, v203
    v_and_b32 v203, s64, v203
    v_pk_mul_f32 v[216:217], v[200:201], v[200:201]
    v_pk_mul_f32 v[218:219], v[202:203], v[202:203]
    v_pk_mul_f32 v[216:217], v[216:217], s[68:69]
    v_pk_mul_f32 v[218:219], v[218:219], s[68:69]
    v_pk_add_f32 v[216:217], v[216:217], s[66:67]
    v_pk_add_f32 v[218:219], v[218:219], s[66:67]
    v_pk_mul_f32 v[216:217], v[216:217], v[200:201]
    v_pk_mul_f32 v[218:219], v[218:219], v[202:203]
    v_exp_f32 v216, v216
    v_exp_f32 v217, v217
    v_exp_f32 v218, v218
    v_exp_f32 v219, v219
    v_lshlrev_b32 v208, 16, v209
    v_and_b32 v209, s64, v209
    v_lshlrev_b32 v210, 16, v211
    v_and_b32 v211, s64, v211
    v_pk_add_f32 v[216:217], v[216:217], 1.0 op_sel_hi:[1,0]
    v_pk_add_f32 v[218:219], v[218:219], 1.0 op_sel_hi:[1,0]
    v_rcp_f32 v216, v216
    v_rcp_f32 v217, v217
    v_rcp_f32 v218, v218
    v_rcp_f32 v219, v219
    v_pk_mul_f32 v[216:217], v[216:217], v[200:201]
    v_pk_mul_f32 v[218:219], v[218:219], v[202:203]
    v_cvt_pk_bf16_f32 v217, v216, v217
    v_cvt_pk_bf16_f32 v219, v218, v219
    v_lshlrev_b32 v216, 16, v217
    v_and_b32 v217, s64, v217
    v_lshlrev_b32 v218, 16, v219
    v_and_b32 v219, s64, v219
    v_pk_mul_f32 v[216:217], v[216:217], v[208:209]
    v_pk_mul_f32 v[218:219], v[218:219], v[210:211]
    v_cvt_pk_bf16_f32 v222, v216, v217
    v_cvt_pk_bf16_f32 v223, v218, v219
    buffer_store_dwordx2 v[222:223], v21, s[40:43], 0 offen offset:96
    v_cvt_pk_bf16_f32 v197, v72, v73
    v_cvt_pk_bf16_f32 v205, v128, v129
    v_cvt_pk_bf16_f32 v199, v74, v75
    v_cvt_pk_bf16_f32 v207, v130, v131
    v_lshlrev_b32 v196, 16, v197
    v_and_b32 v197, s64, v197
    v_lshlrev_b32 v198, 16, v199
    v_and_b32 v199, s64, v199
    v_pk_mul_f32 v[212:213], v[196:197], v[196:197]
    v_pk_mul_f32 v[214:215], v[198:199], v[198:199]
    v_pk_mul_f32 v[212:213], v[212:213], s[68:69]
    v_pk_mul_f32 v[214:215], v[214:215], s[68:69]
    v_pk_add_f32 v[212:213], v[212:213], s[66:67]
    v_pk_add_f32 v[214:215], v[214:215], s[66:67]
    v_pk_mul_f32 v[212:213], v[212:213], v[196:197]
    v_pk_mul_f32 v[214:215], v[214:215], v[198:199]
    v_exp_f32 v212, v212
    v_exp_f32 v213, v213
    v_exp_f32 v214, v214
    v_exp_f32 v215, v215
    v_lshlrev_b32 v204, 16, v205
    v_and_b32 v205, s64, v205
    v_lshlrev_b32 v206, 16, v207
    v_and_b32 v207, s64, v207
    v_pk_add_f32 v[212:213], v[212:213], 1.0 op_sel_hi:[1,0]
    v_pk_add_f32 v[214:215], v[214:215], 1.0 op_sel_hi:[1,0]
    v_rcp_f32 v212, v212
    v_rcp_f32 v213, v213
    v_rcp_f32 v214, v214
    v_rcp_f32 v215, v215
    v_pk_mul_f32 v[212:213], v[212:213], v[196:197]
    v_pk_mul_f32 v[214:215], v[214:215], v[198:199]
    v_cvt_pk_bf16_f32 v213, v212, v213
    v_cvt_pk_bf16_f32 v215, v214, v215
    v_lshlrev_b32 v212, 16, v213
    v_and_b32 v213, s64, v213
    v_lshlrev_b32 v214, 16, v215
    v_and_b32 v215, s64, v215
    v_pk_mul_f32 v[212:213], v[212:213], v[204:205]
    v_pk_mul_f32 v[214:215], v[214:215], v[206:207]
    v_cvt_pk_bf16_f32 v220, v212, v213
    v_cvt_pk_bf16_f32 v221, v214, v215
    buffer_store_dwordx2 v[220:221], v21, s[40:43], 0 offen offset:128
    v_cvt_pk_bf16_f32 v201, v80, v81
    v_cvt_pk_bf16_f32 v209, v136, v137
    v_cvt_pk_bf16_f32 v203, v82, v83
    v_cvt_pk_bf16_f32 v211, v138, v139
    v_lshlrev_b32 v200, 16, v201
    v_and_b32 v201, s64, v201
    v_lshlrev_b32 v202, 16, v203
    v_and_b32 v203, s64, v203
    v_pk_mul_f32 v[216:217], v[200:201], v[200:201]
    v_pk_mul_f32 v[218:219], v[202:203], v[202:203]
    v_pk_mul_f32 v[216:217], v[216:217], s[68:69]
    v_pk_mul_f32 v[218:219], v[218:219], s[68:69]
    v_pk_add_f32 v[216:217], v[216:217], s[66:67]
    v_pk_add_f32 v[218:219], v[218:219], s[66:67]
    v_pk_mul_f32 v[216:217], v[216:217], v[200:201]
    v_pk_mul_f32 v[218:219], v[218:219], v[202:203]
    v_exp_f32 v216, v216
    v_exp_f32 v217, v217
    v_exp_f32 v218, v218
    v_exp_f32 v219, v219
    v_lshlrev_b32 v208, 16, v209
    v_and_b32 v209, s64, v209
    v_lshlrev_b32 v210, 16, v211
    v_and_b32 v211, s64, v211
    v_pk_add_f32 v[216:217], v[216:217], 1.0 op_sel_hi:[1,0]
    v_pk_add_f32 v[218:219], v[218:219], 1.0 op_sel_hi:[1,0]
    v_rcp_f32 v216, v216
    v_rcp_f32 v217, v217
    v_rcp_f32 v218, v218
    v_rcp_f32 v219, v219
    v_pk_mul_f32 v[216:217], v[216:217], v[200:201]
    v_pk_mul_f32 v[218:219], v[218:219], v[202:203]
    v_cvt_pk_bf16_f32 v217, v216, v217
    v_cvt_pk_bf16_f32 v219, v218, v219
    v_lshlrev_b32 v216, 16, v217
    v_and_b32 v217, s64, v217
    v_lshlrev_b32 v218, 16, v219
    v_and_b32 v219, s64, v219
    v_pk_mul_f32 v[216:217], v[216:217], v[208:209]
    v_pk_mul_f32 v[218:219], v[218:219], v[210:211]
    v_cvt_pk_bf16_f32 v222, v216, v217
    v_cvt_pk_bf16_f32 v223, v218, v219
    buffer_store_dwordx2 v[222:223], v21, s[40:43], 0 offen offset:160
    v_cvt_pk_bf16_f32 v197, v88, v89
    v_cvt_pk_bf16_f32 v205, v144, v145
    v_cvt_pk_bf16_f32 v199, v90, v91
    v_cvt_pk_bf16_f32 v207, v146, v147
    v_lshlrev_b32 v196, 16, v197
    v_and_b32 v197, s64, v197
    v_lshlrev_b32 v198, 16, v199
    v_and_b32 v199, s64, v199
    v_pk_mul_f32 v[212:213], v[196:197], v[196:197]
    v_pk_mul_f32 v[214:215], v[198:199], v[198:199]
    v_pk_mul_f32 v[212:213], v[212:213], s[68:69]
    v_pk_mul_f32 v[214:215], v[214:215], s[68:69]
    v_pk_add_f32 v[212:213], v[212:213], s[66:67]
    v_pk_add_f32 v[214:215], v[214:215], s[66:67]
    v_pk_mul_f32 v[212:213], v[212:213], v[196:197]
    v_pk_mul_f32 v[214:215], v[214:215], v[198:199]
    v_exp_f32 v212, v212
    v_exp_f32 v213, v213
    v_exp_f32 v214, v214
    v_exp_f32 v215, v215
    v_lshlrev_b32 v204, 16, v205
    v_and_b32 v205, s64, v205
    v_lshlrev_b32 v206, 16, v207
    v_and_b32 v207, s64, v207
    v_pk_add_f32 v[212:213], v[212:213], 1.0 op_sel_hi:[1,0]
    v_pk_add_f32 v[214:215], v[214:215], 1.0 op_sel_hi:[1,0]
    v_rcp_f32 v212, v212
    v_rcp_f32 v213, v213
    v_rcp_f32 v214, v214
    v_rcp_f32 v215, v215
    v_pk_mul_f32 v[212:213], v[212:213], v[196:197]
    v_pk_mul_f32 v[214:215], v[214:215], v[198:199]
    v_cvt_pk_bf16_f32 v213, v212, v213
    v_cvt_pk_bf16_f32 v215, v214, v215
    v_lshlrev_b32 v212, 16, v213
    v_and_b32 v213, s64, v213
    v_lshlrev_b32 v214, 16, v215
    v_and_b32 v215, s64, v215
    v_pk_mul_f32 v[212:213], v[212:213], v[204:205]
    v_pk_mul_f32 v[214:215], v[214:215], v[206:207]
    v_cvt_pk_bf16_f32 v220, v212, v213
    v_cvt_pk_bf16_f32 v221, v214, v215
    buffer_store_dwordx2 v[220:221], v21, s[40:43], 0 offen offset:192
    v_cvt_pk_bf16_f32 v201, v44, v45
    v_cvt_pk_bf16_f32 v209, v100, v101
    v_cvt_pk_bf16_f32 v203, v46, v47
    v_cvt_pk_bf16_f32 v211, v102, v103
    v_lshlrev_b32 v200, 16, v201
    v_and_b32 v201, s64, v201
    v_lshlrev_b32 v202, 16, v203
    v_and_b32 v203, s64, v203
    v_pk_mul_f32 v[216:217], v[200:201], v[200:201]
    v_pk_mul_f32 v[218:219], v[202:203], v[202:203]
    v_pk_mul_f32 v[216:217], v[216:217], s[68:69]
    v_pk_mul_f32 v[218:219], v[218:219], s[68:69]
    v_pk_add_f32 v[216:217], v[216:217], s[66:67]
    v_pk_add_f32 v[218:219], v[218:219], s[66:67]
    v_pk_mul_f32 v[216:217], v[216:217], v[200:201]
    v_pk_mul_f32 v[218:219], v[218:219], v[202:203]
    v_exp_f32 v216, v216
    v_exp_f32 v217, v217
    v_exp_f32 v218, v218
    v_exp_f32 v219, v219
    v_lshlrev_b32 v208, 16, v209
    v_and_b32 v209, s64, v209
    v_lshlrev_b32 v210, 16, v211
    v_and_b32 v211, s64, v211
    v_pk_add_f32 v[216:217], v[216:217], 1.0 op_sel_hi:[1,0]
    v_pk_add_f32 v[218:219], v[218:219], 1.0 op_sel_hi:[1,0]
    v_rcp_f32 v216, v216
    v_rcp_f32 v217, v217
    v_rcp_f32 v218, v218
    v_rcp_f32 v219, v219
    v_pk_mul_f32 v[216:217], v[216:217], v[200:201]
    v_pk_mul_f32 v[218:219], v[218:219], v[202:203]
    v_cvt_pk_bf16_f32 v217, v216, v217
    v_cvt_pk_bf16_f32 v219, v218, v219
    v_lshlrev_b32 v216, 16, v217
    v_and_b32 v217, s64, v217
    v_lshlrev_b32 v218, 16, v219
    v_and_b32 v219, s64, v219
    v_pk_mul_f32 v[216:217], v[216:217], v[208:209]
    v_pk_mul_f32 v[218:219], v[218:219], v[210:211]
    v_cvt_pk_bf16_f32 v222, v216, v217
    v_cvt_pk_bf16_f32 v223, v218, v219
    buffer_store_dwordx2 v[222:223], v22, s[40:43], 0 offen offset:0
    v_cvt_pk_bf16_f32 v197, v52, v53
    v_cvt_pk_bf16_f32 v205, v108, v109
    v_cvt_pk_bf16_f32 v199, v54, v55
    v_cvt_pk_bf16_f32 v207, v110, v111
    v_lshlrev_b32 v196, 16, v197
    v_and_b32 v197, s64, v197
    v_lshlrev_b32 v198, 16, v199
    v_and_b32 v199, s64, v199
    v_pk_mul_f32 v[212:213], v[196:197], v[196:197]
    v_pk_mul_f32 v[214:215], v[198:199], v[198:199]
    v_pk_mul_f32 v[212:213], v[212:213], s[68:69]
    v_pk_mul_f32 v[214:215], v[214:215], s[68:69]
    v_pk_add_f32 v[212:213], v[212:213], s[66:67]
    v_pk_add_f32 v[214:215], v[214:215], s[66:67]
    v_pk_mul_f32 v[212:213], v[212:213], v[196:197]
    v_pk_mul_f32 v[214:215], v[214:215], v[198:199]
    v_exp_f32 v212, v212
    v_exp_f32 v213, v213
    v_exp_f32 v214, v214
    v_exp_f32 v215, v215
    v_lshlrev_b32 v204, 16, v205
    v_and_b32 v205, s64, v205
    v_lshlrev_b32 v206, 16, v207
    v_and_b32 v207, s64, v207
    v_pk_add_f32 v[212:213], v[212:213], 1.0 op_sel_hi:[1,0]
    v_pk_add_f32 v[214:215], v[214:215], 1.0 op_sel_hi:[1,0]
    v_rcp_f32 v212, v212
    v_rcp_f32 v213, v213
    v_rcp_f32 v214, v214
    v_rcp_f32 v215, v215
    v_pk_mul_f32 v[212:213], v[212:213], v[196:197]
    v_pk_mul_f32 v[214:215], v[214:215], v[198:199]
    v_cvt_pk_bf16_f32 v213, v212, v213
    v_cvt_pk_bf16_f32 v215, v214, v215
    v_lshlrev_b32 v212, 16, v213
    v_and_b32 v213, s64, v213
    v_lshlrev_b32 v214, 16, v215
    v_and_b32 v215, s64, v215
    v_pk_mul_f32 v[212:213], v[212:213], v[204:205]
    v_pk_mul_f32 v[214:215], v[214:215], v[206:207]
    v_cvt_pk_bf16_f32 v220, v212, v213
    v_cvt_pk_bf16_f32 v221, v214, v215
    buffer_store_dwordx2 v[220:221], v22, s[40:43], 0 offen offset:32
    v_cvt_pk_bf16_f32 v201, v60, v61
    v_cvt_pk_bf16_f32 v209, v116, v117
    v_cvt_pk_bf16_f32 v203, v62, v63
    v_cvt_pk_bf16_f32 v211, v118, v119
    v_lshlrev_b32 v200, 16, v201
    v_and_b32 v201, s64, v201
    v_lshlrev_b32 v202, 16, v203
    v_and_b32 v203, s64, v203
    v_pk_mul_f32 v[216:217], v[200:201], v[200:201]
    v_pk_mul_f32 v[218:219], v[202:203], v[202:203]
    v_pk_mul_f32 v[216:217], v[216:217], s[68:69]
    v_pk_mul_f32 v[218:219], v[218:219], s[68:69]
    v_pk_add_f32 v[216:217], v[216:217], s[66:67]
    v_pk_add_f32 v[218:219], v[218:219], s[66:67]
    v_pk_mul_f32 v[216:217], v[216:217], v[200:201]
    v_pk_mul_f32 v[218:219], v[218:219], v[202:203]
    v_exp_f32 v216, v216
    v_exp_f32 v217, v217
    v_exp_f32 v218, v218
    v_exp_f32 v219, v219
    v_lshlrev_b32 v208, 16, v209
    v_and_b32 v209, s64, v209
    v_lshlrev_b32 v210, 16, v211
    v_and_b32 v211, s64, v211
    v_pk_add_f32 v[216:217], v[216:217], 1.0 op_sel_hi:[1,0]
    v_pk_add_f32 v[218:219], v[218:219], 1.0 op_sel_hi:[1,0]
    v_rcp_f32 v216, v216
    v_rcp_f32 v217, v217
    v_rcp_f32 v218, v218
    v_rcp_f32 v219, v219
    v_pk_mul_f32 v[216:217], v[216:217], v[200:201]
    v_pk_mul_f32 v[218:219], v[218:219], v[202:203]
    v_cvt_pk_bf16_f32 v217, v216, v217
    v_cvt_pk_bf16_f32 v219, v218, v219
    v_lshlrev_b32 v216, 16, v217
    v_and_b32 v217, s64, v217
    v_lshlrev_b32 v218, 16, v219
    v_and_b32 v219, s64, v219
    v_pk_mul_f32 v[216:217], v[216:217], v[208:209]
    v_pk_mul_f32 v[218:219], v[218:219], v[210:211]
    v_cvt_pk_bf16_f32 v222, v216, v217
    v_cvt_pk_bf16_f32 v223, v218, v219
    buffer_store_dwordx2 v[222:223], v22, s[40:43], 0 offen offset:64
    v_cvt_pk_bf16_f32 v197, v68, v69
    v_cvt_pk_bf16_f32 v205, v124, v125
    v_cvt_pk_bf16_f32 v199, v70, v71
    v_cvt_pk_bf16_f32 v207, v126, v127
    v_lshlrev_b32 v196, 16, v197
    v_and_b32 v197, s64, v197
    v_lshlrev_b32 v198, 16, v199
    v_and_b32 v199, s64, v199
    v_pk_mul_f32 v[212:213], v[196:197], v[196:197]
    v_pk_mul_f32 v[214:215], v[198:199], v[198:199]
    v_pk_mul_f32 v[212:213], v[212:213], s[68:69]
    v_pk_mul_f32 v[214:215], v[214:215], s[68:69]
    v_pk_add_f32 v[212:213], v[212:213], s[66:67]
    v_pk_add_f32 v[214:215], v[214:215], s[66:67]
    v_pk_mul_f32 v[212:213], v[212:213], v[196:197]
    v_pk_mul_f32 v[214:215], v[214:215], v[198:199]
    v_exp_f32 v212, v212
    v_exp_f32 v213, v213
    v_exp_f32 v214, v214
    v_exp_f32 v215, v215
    v_lshlrev_b32 v204, 16, v205
    v_and_b32 v205, s64, v205
    v_lshlrev_b32 v206, 16, v207
    v_and_b32 v207, s64, v207
    v_pk_add_f32 v[212:213], v[212:213], 1.0 op_sel_hi:[1,0]
    v_pk_add_f32 v[214:215], v[214:215], 1.0 op_sel_hi:[1,0]
    v_rcp_f32 v212, v212
    v_rcp_f32 v213, v213
    v_rcp_f32 v214, v214
    v_rcp_f32 v215, v215
    v_pk_mul_f32 v[212:213], v[212:213], v[196:197]
    v_pk_mul_f32 v[214:215], v[214:215], v[198:199]
    v_cvt_pk_bf16_f32 v213, v212, v213
    v_cvt_pk_bf16_f32 v215, v214, v215
    v_lshlrev_b32 v212, 16, v213
    v_and_b32 v213, s64, v213
    v_lshlrev_b32 v214, 16, v215
    v_and_b32 v215, s64, v215
    v_pk_mul_f32 v[212:213], v[212:213], v[204:205]
    v_pk_mul_f32 v[214:215], v[214:215], v[206:207]
    v_cvt_pk_bf16_f32 v220, v212, v213
    v_cvt_pk_bf16_f32 v221, v214, v215
    buffer_store_dwordx2 v[220:221], v22, s[40:43], 0 offen offset:96
    v_cvt_pk_bf16_f32 v201, v76, v77
    v_cvt_pk_bf16_f32 v209, v132, v133
    v_cvt_pk_bf16_f32 v203, v78, v79
    v_cvt_pk_bf16_f32 v211, v134, v135
    v_lshlrev_b32 v200, 16, v201
    v_and_b32 v201, s64, v201
    v_lshlrev_b32 v202, 16, v203
    v_and_b32 v203, s64, v203
    v_pk_mul_f32 v[216:217], v[200:201], v[200:201]
    v_pk_mul_f32 v[218:219], v[202:203], v[202:203]
    v_pk_mul_f32 v[216:217], v[216:217], s[68:69]
    v_pk_mul_f32 v[218:219], v[218:219], s[68:69]
    v_pk_add_f32 v[216:217], v[216:217], s[66:67]
    v_pk_add_f32 v[218:219], v[218:219], s[66:67]
    v_pk_mul_f32 v[216:217], v[216:217], v[200:201]
    v_pk_mul_f32 v[218:219], v[218:219], v[202:203]
    v_exp_f32 v216, v216
    v_exp_f32 v217, v217
    v_exp_f32 v218, v218
    v_exp_f32 v219, v219
    v_lshlrev_b32 v208, 16, v209
    v_and_b32 v209, s64, v209
    v_lshlrev_b32 v210, 16, v211
    v_and_b32 v211, s64, v211
    v_pk_add_f32 v[216:217], v[216:217], 1.0 op_sel_hi:[1,0]
    v_pk_add_f32 v[218:219], v[218:219], 1.0 op_sel_hi:[1,0]
    v_rcp_f32 v216, v216
    v_rcp_f32 v217, v217
    v_rcp_f32 v218, v218
    v_rcp_f32 v219, v219
    v_pk_mul_f32 v[216:217], v[216:217], v[200:201]
    v_pk_mul_f32 v[218:219], v[218:219], v[202:203]
    v_cvt_pk_bf16_f32 v217, v216, v217
    v_cvt_pk_bf16_f32 v219, v218, v219
    v_lshlrev_b32 v216, 16, v217
    v_and_b32 v217, s64, v217
    v_lshlrev_b32 v218, 16, v219
    v_and_b32 v219, s64, v219
    v_pk_mul_f32 v[216:217], v[216:217], v[208:209]
    v_pk_mul_f32 v[218:219], v[218:219], v[210:211]
    v_cvt_pk_bf16_f32 v222, v216, v217
    v_cvt_pk_bf16_f32 v223, v218, v219
    buffer_store_dwordx2 v[222:223], v22, s[40:43], 0 offen offset:128
    v_cvt_pk_bf16_f32 v197, v84, v85
    v_cvt_pk_bf16_f32 v205, v140, v141
    v_cvt_pk_bf16_f32 v199, v86, v87
    v_cvt_pk_bf16_f32 v207, v142, v143
    v_lshlrev_b32 v196, 16, v197
    v_and_b32 v197, s64, v197
    v_lshlrev_b32 v198, 16, v199
    v_and_b32 v199, s64, v199
    v_pk_mul_f32 v[212:213], v[196:197], v[196:197]
    v_pk_mul_f32 v[214:215], v[198:199], v[198:199]
    v_pk_mul_f32 v[212:213], v[212:213], s[68:69]
    v_pk_mul_f32 v[214:215], v[214:215], s[68:69]
    v_pk_add_f32 v[212:213], v[212:213], s[66:67]
    v_pk_add_f32 v[214:215], v[214:215], s[66:67]
    v_pk_mul_f32 v[212:213], v[212:213], v[196:197]
    v_pk_mul_f32 v[214:215], v[214:215], v[198:199]
    v_exp_f32 v212, v212
    v_exp_f32 v213, v213
    v_exp_f32 v214, v214
    v_exp_f32 v215, v215
    v_lshlrev_b32 v204, 16, v205
    v_and_b32 v205, s64, v205
    v_lshlrev_b32 v206, 16, v207
    v_and_b32 v207, s64, v207
    v_pk_add_f32 v[212:213], v[212:213], 1.0 op_sel_hi:[1,0]
    v_pk_add_f32 v[214:215], v[214:215], 1.0 op_sel_hi:[1,0]
    v_rcp_f32 v212, v212
    v_rcp_f32 v213, v213
    v_rcp_f32 v214, v214
    v_rcp_f32 v215, v215
    v_pk_mul_f32 v[212:213], v[212:213], v[196:197]
    v_pk_mul_f32 v[214:215], v[214:215], v[198:199]
    v_cvt_pk_bf16_f32 v213, v212, v213
    v_cvt_pk_bf16_f32 v215, v214, v215
    v_lshlrev_b32 v212, 16, v213
    v_and_b32 v213, s64, v213
    v_lshlrev_b32 v214, 16, v215
    v_and_b32 v215, s64, v215
    v_pk_mul_f32 v[212:213], v[212:213], v[204:205]
    v_pk_mul_f32 v[214:215], v[214:215], v[206:207]
    v_cvt_pk_bf16_f32 v220, v212, v213
    v_cvt_pk_bf16_f32 v221, v214, v215
    buffer_store_dwordx2 v[220:221], v22, s[40:43], 0 offen offset:160
    v_cvt_pk_bf16_f32 v201, v92, v93
    v_cvt_pk_bf16_f32 v209, v148, v149
    v_cvt_pk_bf16_f32 v203, v94, v95
    v_cvt_pk_bf16_f32 v211, v150, v151
    v_lshlrev_b32 v200, 16, v201
    v_and_b32 v201, s64, v201
    v_lshlrev_b32 v202, 16, v203
    v_and_b32 v203, s64, v203
    v_pk_mul_f32 v[216:217], v[200:201], v[200:201]
    v_pk_mul_f32 v[218:219], v[202:203], v[202:203]
    v_pk_mul_f32 v[216:217], v[216:217], s[68:69]
    v_pk_mul_f32 v[218:219], v[218:219], s[68:69]
    v_pk_add_f32 v[216:217], v[216:217], s[66:67]
    v_pk_add_f32 v[218:219], v[218:219], s[66:67]
    v_pk_mul_f32 v[216:217], v[216:217], v[200:201]
    v_pk_mul_f32 v[218:219], v[218:219], v[202:203]
    v_exp_f32 v216, v216
    v_exp_f32 v217, v217
    v_exp_f32 v218, v218
    v_exp_f32 v219, v219
    v_lshlrev_b32 v208, 16, v209
    v_and_b32 v209, s64, v209
    v_lshlrev_b32 v210, 16, v211
    v_and_b32 v211, s64, v211
    v_pk_add_f32 v[216:217], v[216:217], 1.0 op_sel_hi:[1,0]
    v_pk_add_f32 v[218:219], v[218:219], 1.0 op_sel_hi:[1,0]
    v_rcp_f32 v216, v216
    v_rcp_f32 v217, v217
    v_rcp_f32 v218, v218
    v_rcp_f32 v219, v219
    v_pk_mul_f32 v[216:217], v[216:217], v[200:201]
    v_pk_mul_f32 v[218:219], v[218:219], v[202:203]
    v_cvt_pk_bf16_f32 v217, v216, v217
    v_cvt_pk_bf16_f32 v219, v218, v219
    v_lshlrev_b32 v216, 16, v217
    v_and_b32 v217, s64, v217
    v_lshlrev_b32 v218, 16, v219
    v_and_b32 v219, s64, v219
    v_pk_mul_f32 v[216:217], v[216:217], v[208:209]
    v_pk_mul_f32 v[218:219], v[218:219], v[210:211]
    v_cvt_pk_bf16_f32 v222, v216, v217
    v_cvt_pk_bf16_f32 v223, v218, v219
    buffer_store_dwordx2 v[222:223], v22, s[40:43], 0 offen offset:192
    s_waitcnt vmcnt(0)
    s_endpgm
K23_SIDE:
    s_sub_u32 s32, s32, 4
    s_setprio 0
    v_and_b32 v3, 15, v1
    v_lshrrev_b32 v4, 4, v1
    s_lshl_b32 s35, s33, 1
    s_lshr_b32 s34, s32, 1
    s_add_u32 s35, s35, s34
    s_and_b32 s36, s32, 1
    s_lshl_b32 s34, s32, 2
    s_add_u32 s34, s34, 162432
    v_mov_b32 v5, s34
    s_xor_b32 s34, s34, 4
    v_mov_b32 v6, s34
    v_mov_b32 v7, 0
    ds_write_b32 v5, v7
    s_lshl_b32 s38, s35, 8
    s_lshl_b32 s34, s36, 7
    s_add_u32 s38, s38, s34
    v_lshlrev_b32 v8, 1, v1
    s_mov_b32 s40, s6
    s_and_b32 s41, s7, 0xffff
    s_mov_b32 s42, 131072
    s_mov_b32 s43, 0x00020000
    buffer_load_ushort v9, v8, s[40:43], s38 offen
    s_mov_b32 s40, s8
    s_and_b32 s41, s9, 0xffff
    s_mov_b32 s42, 131072
    s_mov_b32 s43, 0x00020000
    buffer_load_ushort v10, v8, s[40:43], s38 offen
    s_mov_b32 s40, s10
    s_and_b32 s41, s11, 0xffff
    s_mov_b32 s42, 131072
    s_mov_b32 s43, 0x00020000
    buffer_load_ushort v11, v8, s[40:43], s38 offen
    s_mov_b32 s40, s12
    s_and_b32 s41, s13, 0xffff
    s_mov_b32 s42, 131072
    s_mov_b32 s43, 0x00020000
    buffer_load_ushort v12, v8, s[40:43], s38 offen
    v_mov_b32 v13, 0
    s_mov_b32 s40, s14
    s_and_b32 s41, s15, 0xffff
    s_mov_b32 s42, 1024
    s_mov_b32 s43, 0x00020000
    s_lshl_b32 s34, s35, 1
    buffer_load_ushort v14, v13, s[40:43], s34 offen
    s_add_u32 s44, s30, 2097152
    s_addc_u32 s45, s31, 0
    s_and_b32 s45, s45, 0xffff
    s_mov_b32 s46, 2129920
    s_mov_b32 s47, 0x00020000
    s_mul_i32 s48, s35, 4160
    s_lshl_b32 s34, s36, 3
    s_add_u32 s48, s48, s34
    s_add_u32 s49, s48, 4096
    v_lshlrev_b32 v15, 4, v1
    buffer_load_dwordx4 v[16:19], v15, s[44:47], s48 offen offset:0
    buffer_load_dwordx4 v[20:23], v15, s[44:47], s48 offen offset:16
    buffer_load_dwordx4 v[24:27], v15, s[44:47], s48 offen offset:1024
    buffer_load_dwordx4 v[28:31], v15, s[44:47], s48 offen offset:1040
    buffer_load_dwordx4 v[32:35], v15, s[44:47], s48 offen offset:2048
    buffer_load_dwordx4 v[36:39], v15, s[44:47], s48 offen offset:2064
    buffer_load_dwordx4 v[40:43], v15, s[44:47], s48 offen offset:3072
    buffer_load_dwordx4 v[44:47], v15, s[44:47], s48 offen offset:3088
    buffer_load_dwordx4 v[48:51], v15, s[44:47], s49 offen offset:0
    buffer_load_dwordx4 v[52:55], v15, s[44:47], s49 offen offset:16
    s_waitcnt lgkmcnt(0)
    s_barrier
    s_mov_b32 s50, 0x3fb8aa3b
    s_mov_b32 s51, 0x32a57060
    s_mov_b32 s52, 0x3f317218
    s_mov_b32 s53, 0x3e22f983
    s_mov_b32 s54, 0x31dc9c88
    v_lshlrev_b32 v56, 3, v3
    v_cvt_f32_u32 v56, v56
    v_lshlrev_b32 v59, 1, v3
    v_add_u32 v59, 240, v59
    v_and_b32 v60, 1, v3
    v_lshlrev_b32 v60, 2, v60
    v_bfe_u32 v61, v3, 1, 1
    v_lshl_add_u32 v60, v61, 8, v60
    v_add_u32 v60, 512, v60
    v_cmp_gt_u32 vcc, 8, v3
    s_nop 1
    v_cndmask_b32 v57, v59, v3, vcc
    v_cmp_gt_u32 vcc, 12, v3
    s_nop 1
    v_cndmask_b32 v57, v60, v57, vcc
    v_lshlrev_b32 v58, 7, v3
    v_add_u32 v58, 1024, v58
    v_cvt_f32_u32 v57, v57
    v_cvt_f32_u32 v58, v58
    s_waitcnt vmcnt(10)
    v_lshlrev_b32 v14, 16, v14
    v_mul_f32 v59, s50, v14
    v_fma_f32 v60, v14, s50, -v59
    v_fma_f32 v60, v14, s51, v60
    v_exp_f32 v62, v59
    v_mul_f32 v60, s52, v60
    v_fma_f32 v62, v62, v60, v62
    v_cvt_pk_bf16_f32 v62, v62, v62
    v_lshlrev_b32 v62, 16, v62
    v_mul_f32 v63, s50, v62
    v_sub_f32 v63, 0, v63
    v_add_f32 v64, v62, v62
    v_lshlrev_b32 v9, 16, v9
    v_lshlrev_b32 v10, 16, v10
    v_lshlrev_b32 v11, 16, v11
    v_lshlrev_b32 v12, 16, v12
    v_mul_f32 v59, s50, v9
    v_fma_f32 v60, v9, s50, -v59
    v_fma_f32 v60, v9, s51, v60
    v_exp_f32 v65, v59
    v_mul_f32 v60, s52, v60
    v_fma_f32 v65, v65, v60, v65
    v_cvt_pk_bf16_f32 v65, v65, v65
    v_lshlrev_b32 v65, 16, v65
    v_mul_f32 v65, v65, v63
    v_mul_f32 v10, v10, v62
    v_mul_f32 v66, s53, v10
    v_fma_f32 v67, v10, s53, -v66
    v_fma_f32 v67, v10, s54, v67
    v_mul_f32 v11, v11, v64
    v_mul_f32 v12, v12, v64
    s_mov_b32 s55, 0x43000000
    v_mul_f32 v59, s55, v65
    v_exp_f32 v59, v59
    v_mul_f32 v60, s55, v66
    v_fract_f32 v60, v60
    v_fma_f32 v60, v67, s55, v60
    v_sin_f32 v69, v60
    v_cos_f32 v68, v60
    v_mul_f32 v69, v69, v59
    v_mul_f32 v68, v68, v59
    v_mov_b32_dpp v103, v65 row_newbcast:0 row_mask:0xf bank_mask:0xf
    v_mov_b32_dpp v104, v66 row_newbcast:0 row_mask:0xf bank_mask:0xf
    v_mov_b32_dpp v105, v67 row_newbcast:0 row_mask:0xf bank_mask:0xf
    v_mov_b32_dpp v106, v11 row_newbcast:0 row_mask:0xf bank_mask:0xf
    v_mov_b32_dpp v107, v12 row_newbcast:0 row_mask:0xf bank_mask:0xf
    v_mov_b32_dpp v108, v68 row_newbcast:0 row_mask:0xf bank_mask:0xf
    v_mov_b32_dpp v109, v69 row_newbcast:0 row_mask:0xf bank_mask:0xf
    v_mul_f32 v86, v103, v57
    v_mul_f32 v87, v103, v58
    v_mul_f32 v88, v103, v56
    v_mul_f32 v89, v104, v57
    v_mul_f32 v90, v104, v58
    v_mul_f32 v91, v104, v56
    v_exp_f32 v86, v86
    v_exp_f32 v87, v87
    v_exp_f32 v88, v88
    v_fma_f32 v92, v104, v57, -v89
    v_fma_f32 v93, v104, v58, -v90
    v_fma_f32 v94, v104, v56, -v91
    v_fma_f32 v92, v105, v57, v92
    v_fma_f32 v93, v105, v58, v93
    v_fma_f32 v94, v105, v56, v94
    v_fract_f32 v89, v89
    v_fract_f32 v90, v90
    v_fract_f32 v91, v91
    v_add_f32 v89, v89, v92
    v_add_f32 v90, v90, v93
    v_add_f32 v91, v91, v94
    v_sin_f32 v99, v89
    v_sin_f32 v100, v90
    v_sin_f32 v101, v91
    v_cos_f32 v95, v89
    v_cos_f32 v96, v90
    v_cos_f32 v97, v91
    v_mov_b32_dpp v110, v65 row_newbcast:1 row_mask:0xf bank_mask:0xf
    v_mov_b32_dpp v111, v66 row_newbcast:1 row_mask:0xf bank_mask:0xf
    v_mov_b32_dpp v112, v67 row_newbcast:1 row_mask:0xf bank_mask:0xf
    v_mov_b32_dpp v113, v11 row_newbcast:1 row_mask:0xf bank_mask:0xf
    v_mov_b32_dpp v114, v12 row_newbcast:1 row_mask:0xf bank_mask:0xf
    v_mov_b32_dpp v115, v68 row_newbcast:1 row_mask:0xf bank_mask:0xf
    v_mov_b32_dpp v116, v69 row_newbcast:1 row_mask:0xf bank_mask:0xf
    v_mul_f32 v101, v88, v101
    v_mul_f32 v97, v88, v97
    v_mul_f32 v99, v86, v99
    v_mul_f32 v95, v86, v95
    v_mul_f32 v100, v87, v100
    v_mul_f32 v96, v87, v96
    v_mul_f32 v84, v107, v101
    v_mul_f32 v85, v106, v101
    v_mul_f32 v98, v109, v99
    v_mul_f32 v102, v108, v99
    v_fma_f32 v84, v106, v97, -v84
    v_fma_f32 v85, -v107, v97, -v85
    v_fma_f32 v98, v108, v95, -v98
    v_fma_f32 v102, v109, v95, v102
    v_mfma_f32_16x16x4_f32 v[72:75], v95, v84, 0
    v_mfma_f32_16x16x4_f32 v[76:79], v98, v84, 0
    v_mfma_f32_16x16x4_f32 v[80:83], v96, v84, 0
    v_mfma_f32_16x16x4_f32 v[72:75], v99, v85, v[72:75]
    v_mfma_f32_16x16x4_f32 v[76:79], v102, v85, v[76:79]
    v_mfma_f32_16x16x4_f32 v[80:83], v100, v85, v[80:83]
    v_mul_f32 v86, v110, v57
    v_mul_f32 v87, v110, v58
    v_mul_f32 v88, v110, v56
    v_mul_f32 v89, v111, v57
    v_mul_f32 v90, v111, v58
    v_mul_f32 v91, v111, v56
    v_exp_f32 v86, v86
    v_exp_f32 v87, v87
    v_exp_f32 v88, v88
    v_fma_f32 v92, v111, v57, -v89
    v_fma_f32 v93, v111, v58, -v90
    v_fma_f32 v94, v111, v56, -v91
    v_fma_f32 v92, v112, v57, v92
    v_fma_f32 v93, v112, v58, v93
    v_fma_f32 v94, v112, v56, v94
    v_fract_f32 v89, v89
    v_fract_f32 v90, v90
    v_fract_f32 v91, v91
    v_add_f32 v89, v89, v92
    v_add_f32 v90, v90, v93
    v_add_f32 v91, v91, v94
    v_sin_f32 v99, v89
    v_sin_f32 v100, v90
    v_sin_f32 v101, v91
    v_cos_f32 v95, v89
    v_cos_f32 v96, v90
    v_cos_f32 v97, v91
    v_mov_b32_dpp v103, v65 row_newbcast:2 row_mask:0xf bank_mask:0xf
    v_mov_b32_dpp v104, v66 row_newbcast:2 row_mask:0xf bank_mask:0xf
    v_mov_b32_dpp v105, v67 row_newbcast:2 row_mask:0xf bank_mask:0xf
    v_mov_b32_dpp v106, v11 row_newbcast:2 row_mask:0xf bank_mask:0xf
    v_mov_b32_dpp v107, v12 row_newbcast:2 row_mask:0xf bank_mask:0xf
    v_mov_b32_dpp v108, v68 row_newbcast:2 row_mask:0xf bank_mask:0xf
    v_mov_b32_dpp v109, v69 row_newbcast:2 row_mask:0xf bank_mask:0xf
    v_mul_f32 v101, v88, v101
    v_mul_f32 v97, v88, v97
    v_mul_f32 v99, v86, v99
    v_mul_f32 v95, v86, v95
    v_mul_f32 v100, v87, v100
    v_mul_f32 v96, v87, v96
    v_mul_f32 v84, v114, v101
    v_mul_f32 v85, v113, v101
    v_mul_f32 v98, v116, v99
    v_mul_f32 v102, v115, v99
    v_fma_f32 v84, v113, v97, -v84
    v_fma_f32 v85, -v114, v97, -v85
    v_fma_f32 v98, v115, v95, -v98
    v_fma_f32 v102, v116, v95, v102
    v_mfma_f32_16x16x4_f32 v[72:75], v95, v84, v[72:75]
    v_mfma_f32_16x16x4_f32 v[76:79], v98, v84, v[76:79]
    v_mfma_f32_16x16x4_f32 v[80:83], v96, v84, v[80:83]
    v_mfma_f32_16x16x4_f32 v[72:75], v99, v85, v[72:75]
    v_mfma_f32_16x16x4_f32 v[76:79], v102, v85, v[76:79]
    v_mfma_f32_16x16x4_f32 v[80:83], v100, v85, v[80:83]
    v_mul_f32 v86, v103, v57
    v_mul_f32 v87, v103, v58
    v_mul_f32 v88, v103, v56
    v_mul_f32 v89, v104, v57
    v_mul_f32 v90, v104, v58
    v_mul_f32 v91, v104, v56
    v_exp_f32 v86, v86
    v_exp_f32 v87, v87
    v_exp_f32 v88, v88
    v_fma_f32 v92, v104, v57, -v89
    v_fma_f32 v93, v104, v58, -v90
    v_fma_f32 v94, v104, v56, -v91
    v_fma_f32 v92, v105, v57, v92
    v_fma_f32 v93, v105, v58, v93
    v_fma_f32 v94, v105, v56, v94
    v_fract_f32 v89, v89
    v_fract_f32 v90, v90
    v_fract_f32 v91, v91
    v_add_f32 v89, v89, v92
    v_add_f32 v90, v90, v93
    v_add_f32 v91, v91, v94
    v_sin_f32 v99, v89
    v_sin_f32 v100, v90
    v_sin_f32 v101, v91
    v_cos_f32 v95, v89
    v_cos_f32 v96, v90
    v_cos_f32 v97, v91
    v_mov_b32_dpp v110, v65 row_newbcast:3 row_mask:0xf bank_mask:0xf
    v_mov_b32_dpp v111, v66 row_newbcast:3 row_mask:0xf bank_mask:0xf
    v_mov_b32_dpp v112, v67 row_newbcast:3 row_mask:0xf bank_mask:0xf
    v_mov_b32_dpp v113, v11 row_newbcast:3 row_mask:0xf bank_mask:0xf
    v_mov_b32_dpp v114, v12 row_newbcast:3 row_mask:0xf bank_mask:0xf
    v_mov_b32_dpp v115, v68 row_newbcast:3 row_mask:0xf bank_mask:0xf
    v_mov_b32_dpp v116, v69 row_newbcast:3 row_mask:0xf bank_mask:0xf
    v_mul_f32 v101, v88, v101
    v_mul_f32 v97, v88, v97
    v_mul_f32 v99, v86, v99
    v_mul_f32 v95, v86, v95
    v_mul_f32 v100, v87, v100
    v_mul_f32 v96, v87, v96
    v_mul_f32 v84, v107, v101
    v_mul_f32 v85, v106, v101
    v_mul_f32 v98, v109, v99
    v_mul_f32 v102, v108, v99
    v_fma_f32 v84, v106, v97, -v84
    v_fma_f32 v85, -v107, v97, -v85
    v_fma_f32 v98, v108, v95, -v98
    v_fma_f32 v102, v109, v95, v102
    v_mfma_f32_16x16x4_f32 v[72:75], v95, v84, v[72:75]
    v_mfma_f32_16x16x4_f32 v[76:79], v98, v84, v[76:79]
    v_mfma_f32_16x16x4_f32 v[80:83], v96, v84, v[80:83]
    v_mfma_f32_16x16x4_f32 v[72:75], v99, v85, v[72:75]
    v_mfma_f32_16x16x4_f32 v[76:79], v102, v85, v[76:79]
    v_mfma_f32_16x16x4_f32 v[80:83], v100, v85, v[80:83]
    v_mul_f32 v86, v110, v57
    v_mul_f32 v87, v110, v58
    v_mul_f32 v88, v110, v56
    v_mul_f32 v89, v111, v57
    v_mul_f32 v90, v111, v58
    v_mul_f32 v91, v111, v56
    v_exp_f32 v86, v86
    v_exp_f32 v87, v87
    v_exp_f32 v88, v88
    v_fma_f32 v92, v111, v57, -v89
    v_fma_f32 v93, v111, v58, -v90
    v_fma_f32 v94, v111, v56, -v91
    v_fma_f32 v92, v112, v57, v92
    v_fma_f32 v93, v112, v58, v93
    v_fma_f32 v94, v112, v56, v94
    v_fract_f32 v89, v89
    v_fract_f32 v90, v90
    v_fract_f32 v91, v91
    v_add_f32 v89, v89, v92
    v_add_f32 v90, v90, v93
    v_add_f32 v91, v91, v94
    v_sin_f32 v99, v89
    v_sin_f32 v100, v90
    v_sin_f32 v101, v91
    v_cos_f32 v95, v89
    v_cos_f32 v96, v90
    v_cos_f32 v97, v91
    v_mov_b32_dpp v103, v65 row_newbcast:4 row_mask:0xf bank_mask:0xf
    v_mov_b32_dpp v104, v66 row_newbcast:4 row_mask:0xf bank_mask:0xf
    v_mov_b32_dpp v105, v67 row_newbcast:4 row_mask:0xf bank_mask:0xf
    v_mov_b32_dpp v106, v11 row_newbcast:4 row_mask:0xf bank_mask:0xf
    v_mov_b32_dpp v107, v12 row_newbcast:4 row_mask:0xf bank_mask:0xf
    v_mov_b32_dpp v108, v68 row_newbcast:4 row_mask:0xf bank_mask:0xf
    v_mov_b32_dpp v109, v69 row_newbcast:4 row_mask:0xf bank_mask:0xf
    v_mul_f32 v101, v88, v101
    v_mul_f32 v97, v88, v97
    v_mul_f32 v99, v86, v99
    v_mul_f32 v95, v86, v95
    v_mul_f32 v100, v87, v100
    v_mul_f32 v96, v87, v96
    v_mul_f32 v84, v114, v101
    v_mul_f32 v85, v113, v101
    v_mul_f32 v98, v116, v99
    v_mul_f32 v102, v115, v99
    v_fma_f32 v84, v113, v97, -v84
    v_fma_f32 v85, -v114, v97, -v85
    v_fma_f32 v98, v115, v95, -v98
    v_fma_f32 v102, v116, v95, v102
    v_mfma_f32_16x16x4_f32 v[72:75], v95, v84, v[72:75]
    v_mfma_f32_16x16x4_f32 v[76:79], v98, v84, v[76:79]
    v_mfma_f32_16x16x4_f32 v[80:83], v96, v84, v[80:83]
    v_mfma_f32_16x16x4_f32 v[72:75], v99, v85, v[72:75]
    v_mfma_f32_16x16x4_f32 v[76:79], v102, v85, v[76:79]
    v_mfma_f32_16x16x4_f32 v[80:83], v100, v85, v[80:83]
    v_mul_f32 v86, v103, v57
    v_mul_f32 v87, v103, v58
    v_mul_f32 v88, v103, v56
    v_mul_f32 v89, v104, v57
    v_mul_f32 v90, v104, v58
    v_mul_f32 v91, v104, v56
    v_exp_f32 v86, v86
    v_exp_f32 v87, v87
    v_exp_f32 v88, v88
    v_fma_f32 v92, v104, v57, -v89
    v_fma_f32 v93, v104, v58, -v90
    v_fma_f32 v94, v104, v56, -v91
    v_fma_f32 v92, v105, v57, v92
    v_fma_f32 v93, v105, v58, v93
    v_fma_f32 v94, v105, v56, v94
    v_fract_f32 v89, v89
    v_fract_f32 v90, v90
    v_fract_f32 v91, v91
    v_add_f32 v89, v89, v92
    v_add_f32 v90, v90, v93
    v_add_f32 v91, v91, v94
    v_sin_f32 v99, v89
    v_sin_f32 v100, v90
    v_sin_f32 v101, v91
    v_cos_f32 v95, v89
    v_cos_f32 v96, v90
    v_cos_f32 v97, v91
    v_mov_b32_dpp v110, v65 row_newbcast:5 row_mask:0xf bank_mask:0xf
    v_mov_b32_dpp v111, v66 row_newbcast:5 row_mask:0xf bank_mask:0xf
    v_mov_b32_dpp v112, v67 row_newbcast:5 row_mask:0xf bank_mask:0xf
    v_mov_b32_dpp v113, v11 row_newbcast:5 row_mask:0xf bank_mask:0xf
    v_mov_b32_dpp v114, v12 row_newbcast:5 row_mask:0xf bank_mask:0xf
    v_mov_b32_dpp v115, v68 row_newbcast:5 row_mask:0xf bank_mask:0xf
    v_mov_b32_dpp v116, v69 row_newbcast:5 row_mask:0xf bank_mask:0xf
    v_mul_f32 v101, v88, v101
    v_mul_f32 v97, v88, v97
    v_mul_f32 v99, v86, v99
    v_mul_f32 v95, v86, v95
    v_mul_f32 v100, v87, v100
    v_mul_f32 v96, v87, v96
    v_mul_f32 v84, v107, v101
    v_mul_f32 v85, v106, v101
    v_mul_f32 v98, v109, v99
    v_mul_f32 v102, v108, v99
    v_fma_f32 v84, v106, v97, -v84
    v_fma_f32 v85, -v107, v97, -v85
    v_fma_f32 v98, v108, v95, -v98
    v_fma_f32 v102, v109, v95, v102
    v_mfma_f32_16x16x4_f32 v[72:75], v95, v84, v[72:75]
    v_mfma_f32_16x16x4_f32 v[76:79], v98, v84, v[76:79]
    v_mfma_f32_16x16x4_f32 v[80:83], v96, v84, v[80:83]
    v_mfma_f32_16x16x4_f32 v[72:75], v99, v85, v[72:75]
    v_mfma_f32_16x16x4_f32 v[76:79], v102, v85, v[76:79]
    v_mfma_f32_16x16x4_f32 v[80:83], v100, v85, v[80:83]
    v_mul_f32 v86, v110, v57
    v_mul_f32 v87, v110, v58
    v_mul_f32 v88, v110, v56
    v_mul_f32 v89, v111, v57
    v_mul_f32 v90, v111, v58
    v_mul_f32 v91, v111, v56
    v_exp_f32 v86, v86
    v_exp_f32 v87, v87
    v_exp_f32 v88, v88
    v_fma_f32 v92, v111, v57, -v89
    v_fma_f32 v93, v111, v58, -v90
    v_fma_f32 v94, v111, v56, -v91
    v_fma_f32 v92, v112, v57, v92
    v_fma_f32 v93, v112, v58, v93
    v_fma_f32 v94, v112, v56, v94
    v_fract_f32 v89, v89
    v_fract_f32 v90, v90
    v_fract_f32 v91, v91
    v_add_f32 v89, v89, v92
    v_add_f32 v90, v90, v93
    v_add_f32 v91, v91, v94
    v_sin_f32 v99, v89
    v_sin_f32 v100, v90
    v_sin_f32 v101, v91
    v_cos_f32 v95, v89
    v_cos_f32 v96, v90
    v_cos_f32 v97, v91
    v_mov_b32_dpp v103, v65 row_newbcast:6 row_mask:0xf bank_mask:0xf
    v_mov_b32_dpp v104, v66 row_newbcast:6 row_mask:0xf bank_mask:0xf
    v_mov_b32_dpp v105, v67 row_newbcast:6 row_mask:0xf bank_mask:0xf
    v_mov_b32_dpp v106, v11 row_newbcast:6 row_mask:0xf bank_mask:0xf
    v_mov_b32_dpp v107, v12 row_newbcast:6 row_mask:0xf bank_mask:0xf
    v_mov_b32_dpp v108, v68 row_newbcast:6 row_mask:0xf bank_mask:0xf
    v_mov_b32_dpp v109, v69 row_newbcast:6 row_mask:0xf bank_mask:0xf
    v_mul_f32 v101, v88, v101
    v_mul_f32 v97, v88, v97
    v_mul_f32 v99, v86, v99
    v_mul_f32 v95, v86, v95
    v_mul_f32 v100, v87, v100
    v_mul_f32 v96, v87, v96
    v_mul_f32 v84, v114, v101
    v_mul_f32 v85, v113, v101
    v_mul_f32 v98, v116, v99
    v_mul_f32 v102, v115, v99
    v_fma_f32 v84, v113, v97, -v84
    v_fma_f32 v85, -v114, v97, -v85
    v_fma_f32 v98, v115, v95, -v98
    v_fma_f32 v102, v116, v95, v102
    v_mfma_f32_16x16x4_f32 v[72:75], v95, v84, v[72:75]
    v_mfma_f32_16x16x4_f32 v[76:79], v98, v84, v[76:79]
    v_mfma_f32_16x16x4_f32 v[80:83], v96, v84, v[80:83]
    v_mfma_f32_16x16x4_f32 v[72:75], v99, v85, v[72:75]
    v_mfma_f32_16x16x4_f32 v[76:79], v102, v85, v[76:79]
    v_mfma_f32_16x16x4_f32 v[80:83], v100, v85, v[80:83]
    v_mul_f32 v86, v103, v57
    v_mul_f32 v87, v103, v58
    v_mul_f32 v88, v103, v56
    v_mul_f32 v89, v104, v57
    v_mul_f32 v90, v104, v58
    v_mul_f32 v91, v104, v56
    v_exp_f32 v86, v86
    v_exp_f32 v87, v87
    v_exp_f32 v88, v88
    v_fma_f32 v92, v104, v57, -v89
    v_fma_f32 v93, v104, v58, -v90
    v_fma_f32 v94, v104, v56, -v91
    v_fma_f32 v92, v105, v57, v92
    v_fma_f32 v93, v105, v58, v93
    v_fma_f32 v94, v105, v56, v94
    v_fract_f32 v89, v89
    v_fract_f32 v90, v90
    v_fract_f32 v91, v91
    v_add_f32 v89, v89, v92
    v_add_f32 v90, v90, v93
    v_add_f32 v91, v91, v94
    v_sin_f32 v99, v89
    v_sin_f32 v100, v90
    v_sin_f32 v101, v91
    v_cos_f32 v95, v89
    v_cos_f32 v96, v90
    v_cos_f32 v97, v91
    v_mov_b32_dpp v110, v65 row_newbcast:7 row_mask:0xf bank_mask:0xf
    v_mov_b32_dpp v111, v66 row_newbcast:7 row_mask:0xf bank_mask:0xf
    v_mov_b32_dpp v112, v67 row_newbcast:7 row_mask:0xf bank_mask:0xf
    v_mov_b32_dpp v113, v11 row_newbcast:7 row_mask:0xf bank_mask:0xf
    v_mov_b32_dpp v114, v12 row_newbcast:7 row_mask:0xf bank_mask:0xf
    v_mov_b32_dpp v115, v68 row_newbcast:7 row_mask:0xf bank_mask:0xf
    v_mov_b32_dpp v116, v69 row_newbcast:7 row_mask:0xf bank_mask:0xf
    v_mul_f32 v101, v88, v101
    v_mul_f32 v97, v88, v97
    v_mul_f32 v99, v86, v99
    v_mul_f32 v95, v86, v95
    v_mul_f32 v100, v87, v100
    v_mul_f32 v96, v87, v96
    v_mul_f32 v84, v107, v101
    v_mul_f32 v85, v106, v101
    v_mul_f32 v98, v109, v99
    v_mul_f32 v102, v108, v99
    v_fma_f32 v84, v106, v97, -v84
    v_fma_f32 v85, -v107, v97, -v85
    v_fma_f32 v98, v108, v95, -v98
    v_fma_f32 v102, v109, v95, v102
    v_mfma_f32_16x16x4_f32 v[72:75], v95, v84, v[72:75]
    v_mfma_f32_16x16x4_f32 v[76:79], v98, v84, v[76:79]
    v_mfma_f32_16x16x4_f32 v[80:83], v96, v84, v[80:83]
    v_mfma_f32_16x16x4_f32 v[72:75], v99, v85, v[72:75]
    v_mfma_f32_16x16x4_f32 v[76:79], v102, v85, v[76:79]
    v_mfma_f32_16x16x4_f32 v[80:83], v100, v85, v[80:83]
    v_mul_f32 v86, v110, v57
    v_mul_f32 v87, v110, v58
    v_mul_f32 v88, v110, v56
    v_mul_f32 v89, v111, v57
    v_mul_f32 v90, v111, v58
    v_mul_f32 v91, v111, v56
    v_exp_f32 v86, v86
    v_exp_f32 v87, v87
    v_exp_f32 v88, v88
    v_fma_f32 v92, v111, v57, -v89
    v_fma_f32 v93, v111, v58, -v90
    v_fma_f32 v94, v111, v56, -v91
    v_fma_f32 v92, v112, v57, v92
    v_fma_f32 v93, v112, v58, v93
    v_fma_f32 v94, v112, v56, v94
    v_fract_f32 v89, v89
    v_fract_f32 v90, v90
    v_fract_f32 v91, v91
    v_add_f32 v89, v89, v92
    v_add_f32 v90, v90, v93
    v_add_f32 v91, v91, v94
    v_sin_f32 v99, v89
    v_sin_f32 v100, v90
    v_sin_f32 v101, v91
    v_cos_f32 v95, v89
    v_cos_f32 v96, v90
    v_cos_f32 v97, v91
    v_mov_b32_dpp v103, v65 row_newbcast:8 row_mask:0xf bank_mask:0xf
    v_mov_b32_dpp v104, v66 row_newbcast:8 row_mask:0xf bank_mask:0xf
    v_mov_b32_dpp v105, v67 row_newbcast:8 row_mask:0xf bank_mask:0xf
    v_mov_b32_dpp v106, v11 row_newbcast:8 row_mask:0xf bank_mask:0xf
    v_mov_b32_dpp v107, v12 row_newbcast:8 row_mask:0xf bank_mask:0xf
    v_mov_b32_dpp v108, v68 row_newbcast:8 row_mask:0xf bank_mask:0xf
    v_mov_b32_dpp v109, v69 row_newbcast:8 row_mask:0xf bank_mask:0xf
    v_mul_f32 v101, v88, v101
    v_mul_f32 v97, v88, v97
    v_mul_f32 v99, v86, v99
    v_mul_f32 v95, v86, v95
    v_mul_f32 v100, v87, v100
    v_mul_f32 v96, v87, v96
    v_mul_f32 v84, v114, v101
    v_mul_f32 v85, v113, v101
    v_mul_f32 v98, v116, v99
    v_mul_f32 v102, v115, v99
    v_fma_f32 v84, v113, v97, -v84
    v_fma_f32 v85, -v114, v97, -v85
    v_fma_f32 v98, v115, v95, -v98
    v_fma_f32 v102, v116, v95, v102
    v_mfma_f32_16x16x4_f32 v[72:75], v95, v84, v[72:75]
    v_mfma_f32_16x16x4_f32 v[76:79], v98, v84, v[76:79]
    v_mfma_f32_16x16x4_f32 v[80:83], v96, v84, v[80:83]
    v_mfma_f32_16x16x4_f32 v[72:75], v99, v85, v[72:75]
    v_mfma_f32_16x16x4_f32 v[76:79], v102, v85, v[76:79]
    v_mfma_f32_16x16x4_f32 v[80:83], v100, v85, v[80:83]
    v_mul_f32 v86, v103, v57
    v_mul_f32 v87, v103, v58
    v_mul_f32 v88, v103, v56
    v_mul_f32 v89, v104, v57
    v_mul_f32 v90, v104, v58
    v_mul_f32 v91, v104, v56
    v_exp_f32 v86, v86
    v_exp_f32 v87, v87
    v_exp_f32 v88, v88
    v_fma_f32 v92, v104, v57, -v89
    v_fma_f32 v93, v104, v58, -v90
    v_fma_f32 v94, v104, v56, -v91
    v_fma_f32 v92, v105, v57, v92
    v_fma_f32 v93, v105, v58, v93
    v_fma_f32 v94, v105, v56, v94
    v_fract_f32 v89, v89
    v_fract_f32 v90, v90
    v_fract_f32 v91, v91
    v_add_f32 v89, v89, v92
    v_add_f32 v90, v90, v93
    v_add_f32 v91, v91, v94
    v_sin_f32 v99, v89
    v_sin_f32 v100, v90
    v_sin_f32 v101, v91
    v_cos_f32 v95, v89
    v_cos_f32 v96, v90
    v_cos_f32 v97, v91
    v_mov_b32_dpp v110, v65 row_newbcast:9 row_mask:0xf bank_mask:0xf
    v_mov_b32_dpp v111, v66 row_newbcast:9 row_mask:0xf bank_mask:0xf
    v_mov_b32_dpp v112, v67 row_newbcast:9 row_mask:0xf bank_mask:0xf
    v_mov_b32_dpp v113, v11 row_newbcast:9 row_mask:0xf bank_mask:0xf
    v_mov_b32_dpp v114, v12 row_newbcast:9 row_mask:0xf bank_mask:0xf
    v_mov_b32_dpp v115, v68 row_newbcast:9 row_mask:0xf bank_mask:0xf
    v_mov_b32_dpp v116, v69 row_newbcast:9 row_mask:0xf bank_mask:0xf
    v_mul_f32 v101, v88, v101
    v_mul_f32 v97, v88, v97
    v_mul_f32 v99, v86, v99
    v_mul_f32 v95, v86, v95
    v_mul_f32 v100, v87, v100
    v_mul_f32 v96, v87, v96
    v_mul_f32 v84, v107, v101
    v_mul_f32 v85, v106, v101
    v_mul_f32 v98, v109, v99
    v_mul_f32 v102, v108, v99
    v_fma_f32 v84, v106, v97, -v84
    v_fma_f32 v85, -v107, v97, -v85
    v_fma_f32 v98, v108, v95, -v98
    v_fma_f32 v102, v109, v95, v102
    v_mfma_f32_16x16x4_f32 v[72:75], v95, v84, v[72:75]
    v_mfma_f32_16x16x4_f32 v[76:79], v98, v84, v[76:79]
    v_mfma_f32_16x16x4_f32 v[80:83], v96, v84, v[80:83]
    v_mfma_f32_16x16x4_f32 v[72:75], v99, v85, v[72:75]
    v_mfma_f32_16x16x4_f32 v[76:79], v102, v85, v[76:79]
    v_mfma_f32_16x16x4_f32 v[80:83], v100, v85, v[80:83]
    v_mul_f32 v86, v110, v57
    v_mul_f32 v87, v110, v58
    v_mul_f32 v88, v110, v56
    v_mul_f32 v89, v111, v57
    v_mul_f32 v90, v111, v58
    v_mul_f32 v91, v111, v56
    v_exp_f32 v86, v86
    v_exp_f32 v87, v87
    v_exp_f32 v88, v88
    v_fma_f32 v92, v111, v57, -v89
    v_fma_f32 v93, v111, v58, -v90
    v_fma_f32 v94, v111, v56, -v91
    v_fma_f32 v92, v112, v57, v92
    v_fma_f32 v93, v112, v58, v93
    v_fma_f32 v94, v112, v56, v94
    v_fract_f32 v89, v89
    v_fract_f32 v90, v90
    v_fract_f32 v91, v91
    v_add_f32 v89, v89, v92
    v_add_f32 v90, v90, v93
    v_add_f32 v91, v91, v94
    v_sin_f32 v99, v89
    v_sin_f32 v100, v90
    v_sin_f32 v101, v91
    v_cos_f32 v95, v89
    v_cos_f32 v96, v90
    v_cos_f32 v97, v91
    v_mov_b32_dpp v103, v65 row_newbcast:10 row_mask:0xf bank_mask:0xf
    v_mov_b32_dpp v104, v66 row_newbcast:10 row_mask:0xf bank_mask:0xf
    v_mov_b32_dpp v105, v67 row_newbcast:10 row_mask:0xf bank_mask:0xf
    v_mov_b32_dpp v106, v11 row_newbcast:10 row_mask:0xf bank_mask:0xf
    v_mov_b32_dpp v107, v12 row_newbcast:10 row_mask:0xf bank_mask:0xf
    v_mov_b32_dpp v108, v68 row_newbcast:10 row_mask:0xf bank_mask:0xf
    v_mov_b32_dpp v109, v69 row_newbcast:10 row_mask:0xf bank_mask:0xf
    v_mul_f32 v101, v88, v101
    v_mul_f32 v97, v88, v97
    v_mul_f32 v99, v86, v99
    v_mul_f32 v95, v86, v95
    v_mul_f32 v100, v87, v100
    v_mul_f32 v96, v87, v96
    v_mul_f32 v84, v114, v101
    v_mul_f32 v85, v113, v101
    v_mul_f32 v98, v116, v99
    v_mul_f32 v102, v115, v99
    v_fma_f32 v84, v113, v97, -v84
    v_fma_f32 v85, -v114, v97, -v85
    v_fma_f32 v98, v115, v95, -v98
    v_fma_f32 v102, v116, v95, v102
    v_mfma_f32_16x16x4_f32 v[72:75], v95, v84, v[72:75]
    v_mfma_f32_16x16x4_f32 v[76:79], v98, v84, v[76:79]
    v_mfma_f32_16x16x4_f32 v[80:83], v96, v84, v[80:83]
    v_mfma_f32_16x16x4_f32 v[72:75], v99, v85, v[72:75]
    v_mfma_f32_16x16x4_f32 v[76:79], v102, v85, v[76:79]
    v_mfma_f32_16x16x4_f32 v[80:83], v100, v85, v[80:83]
    v_mul_f32 v86, v103, v57
    v_mul_f32 v87, v103, v58
    v_mul_f32 v88, v103, v56
    v_mul_f32 v89, v104, v57
    v_mul_f32 v90, v104, v58
    v_mul_f32 v91, v104, v56
    v_exp_f32 v86, v86
    v_exp_f32 v87, v87
    v_exp_f32 v88, v88
    v_fma_f32 v92, v104, v57, -v89
    v_fma_f32 v93, v104, v58, -v90
    v_fma_f32 v94, v104, v56, -v91
    v_fma_f32 v92, v105, v57, v92
    v_fma_f32 v93, v105, v58, v93
    v_fma_f32 v94, v105, v56, v94
    v_fract_f32 v89, v89
    v_fract_f32 v90, v90
    v_fract_f32 v91, v91
    v_add_f32 v89, v89, v92
    v_add_f32 v90, v90, v93
    v_add_f32 v91, v91, v94
    v_sin_f32 v99, v89
    v_sin_f32 v100, v90
    v_sin_f32 v101, v91
    v_cos_f32 v95, v89
    v_cos_f32 v96, v90
    v_cos_f32 v97, v91
    v_mov_b32_dpp v110, v65 row_newbcast:11 row_mask:0xf bank_mask:0xf
    v_mov_b32_dpp v111, v66 row_newbcast:11 row_mask:0xf bank_mask:0xf
    v_mov_b32_dpp v112, v67 row_newbcast:11 row_mask:0xf bank_mask:0xf
    v_mov_b32_dpp v113, v11 row_newbcast:11 row_mask:0xf bank_mask:0xf
    v_mov_b32_dpp v114, v12 row_newbcast:11 row_mask:0xf bank_mask:0xf
    v_mov_b32_dpp v115, v68 row_newbcast:11 row_mask:0xf bank_mask:0xf
    v_mov_b32_dpp v116, v69 row_newbcast:11 row_mask:0xf bank_mask:0xf
    v_mul_f32 v101, v88, v101
    v_mul_f32 v97, v88, v97
    v_mul_f32 v99, v86, v99
    v_mul_f32 v95, v86, v95
    v_mul_f32 v100, v87, v100
    v_mul_f32 v96, v87, v96
    v_mul_f32 v84, v107, v101
    v_mul_f32 v85, v106, v101
    v_mul_f32 v98, v109, v99
    v_mul_f32 v102, v108, v99
    v_fma_f32 v84, v106, v97, -v84
    v_fma_f32 v85, -v107, v97, -v85
    v_fma_f32 v98, v108, v95, -v98
    v_fma_f32 v102, v109, v95, v102
    v_mfma_f32_16x16x4_f32 v[72:75], v95, v84, v[72:75]
    v_mfma_f32_16x16x4_f32 v[76:79], v98, v84, v[76:79]
    v_mfma_f32_16x16x4_f32 v[80:83], v96, v84, v[80:83]
    v_mfma_f32_16x16x4_f32 v[72:75], v99, v85, v[72:75]
    v_mfma_f32_16x16x4_f32 v[76:79], v102, v85, v[76:79]
    v_mfma_f32_16x16x4_f32 v[80:83], v100, v85, v[80:83]
    v_mul_f32 v86, v110, v57
    v_mul_f32 v87, v110, v58
    v_mul_f32 v88, v110, v56
    v_mul_f32 v89, v111, v57
    v_mul_f32 v90, v111, v58
    v_mul_f32 v91, v111, v56
    v_exp_f32 v86, v86
    v_exp_f32 v87, v87
    v_exp_f32 v88, v88
    v_fma_f32 v92, v111, v57, -v89
    v_fma_f32 v93, v111, v58, -v90
    v_fma_f32 v94, v111, v56, -v91
    v_fma_f32 v92, v112, v57, v92
    v_fma_f32 v93, v112, v58, v93
    v_fma_f32 v94, v112, v56, v94
    v_fract_f32 v89, v89
    v_fract_f32 v90, v90
    v_fract_f32 v91, v91
    v_add_f32 v89, v89, v92
    v_add_f32 v90, v90, v93
    v_add_f32 v91, v91, v94
    v_sin_f32 v99, v89
    v_sin_f32 v100, v90
    v_sin_f32 v101, v91
    v_cos_f32 v95, v89
    v_cos_f32 v96, v90
    v_cos_f32 v97, v91
    v_mov_b32_dpp v103, v65 row_newbcast:12 row_mask:0xf bank_mask:0xf
    v_mov_b32_dpp v104, v66 row_newbcast:12 row_mask:0xf bank_mask:0xf
    v_mov_b32_dpp v105, v67 row_newbcast:12 row_mask:0xf bank_mask:0xf
    v_mov_b32_dpp v106, v11 row_newbcast:12 row_mask:0xf bank_mask:0xf
    v_mov_b32_dpp v107, v12 row_newbcast:12 row_mask:0xf bank_mask:0xf
    v_mov_b32_dpp v108, v68 row_newbcast:12 row_mask:0xf bank_mask:0xf
    v_mov_b32_dpp v109, v69 row_newbcast:12 row_mask:0xf bank_mask:0xf
    v_mul_f32 v101, v88, v101
    v_mul_f32 v97, v88, v97
    v_mul_f32 v99, v86, v99
    v_mul_f32 v95, v86, v95
    v_mul_f32 v100, v87, v100
    v_mul_f32 v96, v87, v96
    v_mul_f32 v84, v114, v101
    v_mul_f32 v85, v113, v101
    v_mul_f32 v98, v116, v99
    v_mul_f32 v102, v115, v99
    v_fma_f32 v84, v113, v97, -v84
    v_fma_f32 v85, -v114, v97, -v85
    v_fma_f32 v98, v115, v95, -v98
    v_fma_f32 v102, v116, v95, v102
    v_mfma_f32_16x16x4_f32 v[72:75], v95, v84, v[72:75]
    v_mfma_f32_16x16x4_f32 v[76:79], v98, v84, v[76:79]
    v_mfma_f32_16x16x4_f32 v[80:83], v96, v84, v[80:83]
    v_mfma_f32_16x16x4_f32 v[72:75], v99, v85, v[72:75]
    v_mfma_f32_16x16x4_f32 v[76:79], v102, v85, v[76:79]
    v_mfma_f32_16x16x4_f32 v[80:83], v100, v85, v[80:83]
    v_mul_f32 v86, v103, v57
    v_mul_f32 v87, v103, v58
    v_mul_f32 v88, v103, v56
    v_mul_f32 v89, v104, v57
    v_mul_f32 v90, v104, v58
    v_mul_f32 v91, v104, v56
    v_exp_f32 v86, v86
    v_exp_f32 v87, v87
    v_exp_f32 v88, v88
    v_fma_f32 v92, v104, v57, -v89
    v_fma_f32 v93, v104, v58, -v90
    v_fma_f32 v94, v104, v56, -v91
    v_fma_f32 v92, v105, v57, v92
    v_fma_f32 v93, v105, v58, v93
    v_fma_f32 v94, v105, v56, v94
    v_fract_f32 v89, v89
    v_fract_f32 v90, v90
    v_fract_f32 v91, v91
    v_add_f32 v89, v89, v92
    v_add_f32 v90, v90, v93
    v_add_f32 v91, v91, v94
    v_sin_f32 v99, v89
    v_sin_f32 v100, v90
    v_sin_f32 v101, v91
    v_cos_f32 v95, v89
    v_cos_f32 v96, v90
    v_cos_f32 v97, v91
    v_mov_b32_dpp v110, v65 row_newbcast:13 row_mask:0xf bank_mask:0xf
    v_mov_b32_dpp v111, v66 row_newbcast:13 row_mask:0xf bank_mask:0xf
    v_mov_b32_dpp v112, v67 row_newbcast:13 row_mask:0xf bank_mask:0xf
    v_mov_b32_dpp v113, v11 row_newbcast:13 row_mask:0xf bank_mask:0xf
    v_mov_b32_dpp v114, v12 row_newbcast:13 row_mask:0xf bank_mask:0xf
    v_mov_b32_dpp v115, v68 row_newbcast:13 row_mask:0xf bank_mask:0xf
    v_mov_b32_dpp v116, v69 row_newbcast:13 row_mask:0xf bank_mask:0xf
    v_mul_f32 v101, v88, v101
    v_mul_f32 v97, v88, v97
    v_mul_f32 v99, v86, v99
    v_mul_f32 v95, v86, v95
    v_mul_f32 v100, v87, v100
    v_mul_f32 v96, v87, v96
    v_mul_f32 v84, v107, v101
    v_mul_f32 v85, v106, v101
    v_mul_f32 v98, v109, v99
    v_mul_f32 v102, v108, v99
    v_fma_f32 v84, v106, v97, -v84
    v_fma_f32 v85, -v107, v97, -v85
    v_fma_f32 v98, v108, v95, -v98
    v_fma_f32 v102, v109, v95, v102
    v_mfma_f32_16x16x4_f32 v[72:75], v95, v84, v[72:75]
    v_mfma_f32_16x16x4_f32 v[76:79], v98, v84, v[76:79]
    v_mfma_f32_16x16x4_f32 v[80:83], v96, v84, v[80:83]
    v_mfma_f32_16x16x4_f32 v[72:75], v99, v85, v[72:75]
    v_mfma_f32_16x16x4_f32 v[76:79], v102, v85, v[76:79]
    v_mfma_f32_16x16x4_f32 v[80:83], v100, v85, v[80:83]
    v_mul_f32 v86, v110, v57
    v_mul_f32 v87, v110, v58
    v_mul_f32 v88, v110, v56
    v_mul_f32 v89, v111, v57
    v_mul_f32 v90, v111, v58
    v_mul_f32 v91, v111, v56
    v_exp_f32 v86, v86
    v_exp_f32 v87, v87
    v_exp_f32 v88, v88
    v_fma_f32 v92, v111, v57, -v89
    v_fma_f32 v93, v111, v58, -v90
    v_fma_f32 v94, v111, v56, -v91
    v_fma_f32 v92, v112, v57, v92
    v_fma_f32 v93, v112, v58, v93
    v_fma_f32 v94, v112, v56, v94
    v_fract_f32 v89, v89
    v_fract_f32 v90, v90
    v_fract_f32 v91, v91
    v_add_f32 v89, v89, v92
    v_add_f32 v90, v90, v93
    v_add_f32 v91, v91, v94
    v_sin_f32 v99, v89
    v_sin_f32 v100, v90
    v_sin_f32 v101, v91
    v_cos_f32 v95, v89
    v_cos_f32 v96, v90
    v_cos_f32 v97, v91
    v_mov_b32_dpp v103, v65 row_newbcast:14 row_mask:0xf bank_mask:0xf
    v_mov_b32_dpp v104, v66 row_newbcast:14 row_mask:0xf bank_mask:0xf
    v_mov_b32_dpp v105, v67 row_newbcast:14 row_mask:0xf bank_mask:0xf
    v_mov_b32_dpp v106, v11 row_newbcast:14 row_mask:0xf bank_mask:0xf
    v_mov_b32_dpp v107, v12 row_newbcast:14 row_mask:0xf bank_mask:0xf
    v_mov_b32_dpp v108, v68 row_newbcast:14 row_mask:0xf bank_mask:0xf
    v_mov_b32_dpp v109, v69 row_newbcast:14 row_mask:0xf bank_mask:0xf
    v_mul_f32 v101, v88, v101
    v_mul_f32 v97, v88, v97
    v_mul_f32 v99, v86, v99
    v_mul_f32 v95, v86, v95
    v_mul_f32 v100, v87, v100
    v_mul_f32 v96, v87, v96
    v_mul_f32 v84, v114, v101
    v_mul_f32 v85, v113, v101
    v_mul_f32 v98, v116, v99
    v_mul_f32 v102, v115, v99
    v_fma_f32 v84, v113, v97, -v84
    v_fma_f32 v85, -v114, v97, -v85
    v_fma_f32 v98, v115, v95, -v98
    v_fma_f32 v102, v116, v95, v102
    v_mfma_f32_16x16x4_f32 v[72:75], v95, v84, v[72:75]
    v_mfma_f32_16x16x4_f32 v[76:79], v98, v84, v[76:79]
    v_mfma_f32_16x16x4_f32 v[80:83], v96, v84, v[80:83]
    v_mfma_f32_16x16x4_f32 v[72:75], v99, v85, v[72:75]
    v_mfma_f32_16x16x4_f32 v[76:79], v102, v85, v[76:79]
    v_mfma_f32_16x16x4_f32 v[80:83], v100, v85, v[80:83]
    v_mul_f32 v86, v103, v57
    v_mul_f32 v87, v103, v58
    v_mul_f32 v88, v103, v56
    v_mul_f32 v89, v104, v57
    v_mul_f32 v90, v104, v58
    v_mul_f32 v91, v104, v56
    v_exp_f32 v86, v86
    v_exp_f32 v87, v87
    v_exp_f32 v88, v88
    v_fma_f32 v92, v104, v57, -v89
    v_fma_f32 v93, v104, v58, -v90
    v_fma_f32 v94, v104, v56, -v91
    v_fma_f32 v92, v105, v57, v92
    v_fma_f32 v93, v105, v58, v93
    v_fma_f32 v94, v105, v56, v94
    v_fract_f32 v89, v89
    v_fract_f32 v90, v90
    v_fract_f32 v91, v91
    v_add_f32 v89, v89, v92
    v_add_f32 v90, v90, v93
    v_add_f32 v91, v91, v94
    v_sin_f32 v99, v89
    v_sin_f32 v100, v90
    v_sin_f32 v101, v91
    v_cos_f32 v95, v89
    v_cos_f32 v96, v90
    v_cos_f32 v97, v91
    v_mov_b32_dpp v110, v65 row_newbcast:15 row_mask:0xf bank_mask:0xf
    v_mov_b32_dpp v111, v66 row_newbcast:15 row_mask:0xf bank_mask:0xf
    v_mov_b32_dpp v112, v67 row_newbcast:15 row_mask:0xf bank_mask:0xf
    v_mov_b32_dpp v113, v11 row_newbcast:15 row_mask:0xf bank_mask:0xf
    v_mov_b32_dpp v114, v12 row_newbcast:15 row_mask:0xf bank_mask:0xf
    v_mov_b32_dpp v115, v68 row_newbcast:15 row_mask:0xf bank_mask:0xf
    v_mov_b32_dpp v116, v69 row_newbcast:15 row_mask:0xf bank_mask:0xf
    v_mul_f32 v101, v88, v101
    v_mul_f32 v97, v88, v97
    v_mul_f32 v99, v86, v99
    v_mul_f32 v95, v86, v95
    v_mul_f32 v100, v87, v100
    v_mul_f32 v96, v87, v96
    v_mul_f32 v84, v107, v101
    v_mul_f32 v85, v106, v101
    v_mul_f32 v98, v109, v99
    v_mul_f32 v102, v108, v99
    v_fma_f32 v84, v106, v97, -v84
    v_fma_f32 v85, -v107, v97, -v85
    v_fma_f32 v98, v108, v95, -v98
    v_fma_f32 v102, v109, v95, v102
    v_mfma_f32_16x16x4_f32 v[72:75], v95, v84, v[72:75]
    v_mfma_f32_16x16x4_f32 v[76:79], v98, v84, v[76:79]
    v_mfma_f32_16x16x4_f32 v[80:83], v96, v84, v[80:83]
    v_mfma_f32_16x16x4_f32 v[72:75], v99, v85, v[72:75]
    v_mfma_f32_16x16x4_f32 v[76:79], v102, v85, v[76:79]
    v_mfma_f32_16x16x4_f32 v[80:83], v100, v85, v[80:83]
    v_mul_f32 v86, v110, v57
    v_mul_f32 v87, v110, v58
    v_mul_f32 v88, v110, v56
    v_mul_f32 v89, v111, v57
    v_mul_f32 v90, v111, v58
    v_mul_f32 v91, v111, v56
    v_exp_f32 v86, v86
    v_exp_f32 v87, v87
    v_exp_f32 v88, v88
    v_fma_f32 v92, v111, v57, -v89
    v_fma_f32 v93, v111, v58, -v90
    v_fma_f32 v94, v111, v56, -v91
    v_fma_f32 v92, v112, v57, v92
    v_fma_f32 v93, v112, v58, v93
    v_fma_f32 v94, v112, v56, v94
    v_fract_f32 v89, v89
    v_fract_f32 v90, v90
    v_fract_f32 v91, v91
    v_add_f32 v89, v89, v92
    v_add_f32 v90, v90, v93
    v_add_f32 v91, v91, v94
    v_sin_f32 v99, v89
    v_sin_f32 v100, v90
    v_sin_f32 v101, v91
    v_cos_f32 v95, v89
    v_cos_f32 v96, v90
    v_cos_f32 v97, v91
    v_mul_f32 v101, v88, v101
    v_mul_f32 v97, v88, v97
    v_mul_f32 v99, v86, v99
    v_mul_f32 v95, v86, v95
    v_mul_f32 v100, v87, v100
    v_mul_f32 v96, v87, v96
    v_mul_f32 v84, v114, v101
    v_mul_f32 v85, v113, v101
    v_mul_f32 v98, v116, v99
    v_mul_f32 v102, v115, v99
    v_fma_f32 v84, v113, v97, -v84
    v_fma_f32 v85, -v114, v97, -v85
    v_fma_f32 v98, v115, v95, -v98
    v_fma_f32 v102, v116, v95, v102
    v_mfma_f32_16x16x4_f32 v[72:75], v95, v84, v[72:75]
    v_mfma_f32_16x16x4_f32 v[76:79], v98, v84, v[76:79]
    v_mfma_f32_16x16x4_f32 v[80:83], v96, v84, v[80:83]
    v_mfma_f32_16x16x4_f32 v[72:75], v99, v85, v[72:75]
    v_mfma_f32_16x16x4_f32 v[76:79], v102, v85, v[76:79]
    v_mfma_f32_16x16x4_f32 v[80:83], v100, v85, v[80:83]
    s_lshr_b32 s56, s32, 1
    s_mul_i32 s56, s56, 8512
    s_add_u32 s56, s56, 135168
    v_mul_u32_u24 v117, 48, v1
    v_add_u32 v117, s56, v117
    s_cmp_eq_u32 s36, 0
    s_nop 3
    s_cbranch_scc1 K23_KG_A
    ds_write_b128 v117, v[72:75] offset:0
    ds_write_b128 v117, v[76:79] offset:16
    ds_write_b128 v117, v[80:83] offset:32
    s_waitcnt lgkmcnt(0)
    v_mov_b32 v7, 1
    ds_write_b32 v5, v7
    s_nop 0
SPIN_8:
    ds_read_b32 v7, v6
    s_waitcnt lgkmcnt(0)
    v_readfirstlane_b32 s37, v7
    s_cmp_lt_u32 s37, 1
    s_cbranch_scc1 SPIN_8
    s_branch K23_KG_B
K23_KG_A:
SPIN_9:
    ds_read_b32 v7, v6
    s_waitcnt lgkmcnt(0)
    v_readfirstlane_b32 s37, v7
    s_cmp_lt_u32 s37, 1
    s_cbranch_scc1 SPIN_9
    ds_read_b128 v[120:123], v117 offset:0
    ds_read_b128 v[124:127], v117 offset:16
    ds_read_b128 v[128:131], v117 offset:32
    s_waitcnt lgkmcnt(0)
    v_add_f32 v72, v72, v120
    v_add_f32 v73, v73, v121
    v_add_f32 v74, v74, v122
    v_add_f32 v75, v75, v123
    v_add_f32 v76, v76, v124
    v_add_f32 v77, v77, v125
    v_add_f32 v78, v78, v126
    v_add_f32 v79, v79, v127
    v_add_f32 v80, v80, v128
    v_add_f32 v81, v81, v129
    v_add_f32 v82, v82, v130
    v_add_f32 v83, v83, v131
    v_max3_f32 v132, |v72|, |v73|, |v74|
    v_max3_f32 v132, |v75|, |v76|, v132
    v_max3_f32 v132, |v77|, |v78|, v132
    v_max3_f32 v132, |v79|, |v80|, v132
    v_max3_f32 v132, |v81|, |v82|, v132
    v_max_f32 v132, |v83|, v132
    s_nop 1
    v_max_f32_dpp v132, v132, v132 quad_perm:[1,0,3,2] row_mask:0xf bank_mask:0xf
    s_nop 1
    v_max_f32_dpp v132, v132, v132 quad_perm:[2,3,0,1] row_mask:0xf bank_mask:0xf
    s_nop 1
    v_max_f32_dpp v132, v132, v132 row_half_mirror row_mask:0xf bank_mask:0xf
    s_nop 1
    v_max_f32_dpp v132, v132, v132 row_mirror row_mask:0xf bank_mask:0xf
    v_mov_b32 v133, v132
    s_nop 1
    v_permlane16_swap_b32 v132, v133
    v_max_f32 v132, v132, v133
    v_mov_b32 v133, v132
    s_nop 1
    v_permlane32_swap_b32 v132, v133
    v_max_f32 v132, v132, v133
    v_bfe_u32 v59, v132, 23, 8
    v_sub_u32 v60, 268, v59
    v_mov_b32 v61, 240
    v_med3_i32 v60, v60, 14, v61
    v_lshlrev_b32 v134, 23, v60
    v_sub_u32 v60, 254, v60
    v_lshlrev_b32 v135, 23, v60
    v_lshlrev_b32 v59, 2, v4
    v_lshl_add_u32 v59, v3, 3, v59
    v_lshlrev_b32 v60, 2, v3
    v_add_u32 v60, 256, v60
    v_mov_b32 v61, 384
    v_lshl_add_u32 v61, v3, 1, v61
    v_cmp_gt_u32 vcc, 2, v4
    s_nop 1
    v_cndmask_b32 v136, v60, v59, vcc
    v_mov_b32 v137, 64
    v_mov_b32 v59, 128
    v_cndmask_b32 v137, v137, v59, vcc
    v_cmp_gt_u32 vcc, 3, v4
    s_nop 1
    v_cndmask_b32 v136, v61, v136, vcc
    v_mov_b32 v59, 32
    v_cndmask_b32 v137, v59, v137, vcc
    v_mov_b32 v59, 62
    v_mov_b32 v60, 0
    v_cndmask_b32 v138, v59, v60, vcc
    v_lshlrev_b32 v136, 2, v136
    v_add_u32 v136, s56, v136
    v_lshlrev_b32 v137, 2, v137
    v_lshlrev_b32 v138, 2, v138
    v_add_u32 v139, v136, v138
    v_add_u32 v140, v136, v137
    v_add_u32 v141, v140, v138
    v_lshl_add_u32 v142, v4, 6, v3
    v_lshlrev_b32 v142, 2, v142
    v_add_u32 v142, s56, v142
    v_mul_f32 v151, v72, v134
    v_mul_f32 v152, v73, v134
    v_mul_f32 v153, v74, v134
    v_mul_f32 v154, v75, v134
    v_cvt_f16_f32 v143, v151
    v_cvt_f16_f32 v144, v152
    v_cvt_f16_f32 v145, v153
    v_cvt_f16_f32 v146, v154
    v_cvt_f32_f16 v147, v143
    v_cvt_f32_f16 v148, v144
    v_cvt_f32_f16 v149, v145
    v_cvt_f32_f16 v150, v146
    v_sub_f32 v147, v151, v147
    v_sub_f32 v148, v152, v148
    v_sub_f32 v149, v153, v149
    v_sub_f32 v150, v154, v150
    v_cvt_f16_f32 v147, v147
    v_cvt_f16_f32 v148, v148
    v_cvt_f16_f32 v149, v149
    v_cvt_f16_f32 v150, v150
    v_pack_b32_f16 v143, v143, v147
    v_pack_b32_f16 v144, v144, v148
    v_pack_b32_f16 v145, v145, v149
    v_pack_b32_f16 v146, v146, v150
    ds_write_b32 v136, v143 offset:0
    ds_write_b32 v136, v144 offset:4
    ds_write_b32 v139, v145 offset:8
    ds_write_b32 v139, v146 offset:12
    v_mul_f32 v151, v76, v134
    v_mul_f32 v152, v77, v134
    v_mul_f32 v153, v78, v134
    v_mul_f32 v154, v79, v134
    v_cvt_f16_f32 v143, v151
    v_cvt_f16_f32 v144, v152
    v_cvt_f16_f32 v145, v153
    v_cvt_f16_f32 v146, v154
    v_cvt_f32_f16 v147, v143
    v_cvt_f32_f16 v148, v144
    v_cvt_f32_f16 v149, v145
    v_cvt_f32_f16 v150, v146
    v_sub_f32 v147, v151, v147
    v_sub_f32 v148, v152, v148
    v_sub_f32 v149, v153, v149
    v_sub_f32 v150, v154, v150
    v_cvt_f16_f32 v147, v147
    v_cvt_f16_f32 v148, v148
    v_cvt_f16_f32 v149, v149
    v_cvt_f16_f32 v150, v150
    v_pack_b32_f16 v143, v143, v147
    v_pack_b32_f16 v144, v144, v148
    v_pack_b32_f16 v145, v145, v149
    v_pack_b32_f16 v146, v146, v150
    ds_write_b32 v140, v143 offset:0
    ds_write_b32 v140, v144 offset:4
    ds_write_b32 v141, v145 offset:8
    ds_write_b32 v141, v146 offset:12
    v_mul_f32 v151, v80, v134
    v_mul_f32 v152, v81, v134
    v_mul_f32 v153, v82, v134
    v_mul_f32 v154, v83, v134
    v_cvt_f16_f32 v143, v151
    v_cvt_f16_f32 v144, v152
    v_cvt_f16_f32 v145, v153
    v_cvt_f16_f32 v146, v154
    v_cvt_f32_f16 v147, v143
    v_cvt_f32_f16 v148, v144
    v_cvt_f32_f16 v149, v145
    v_cvt_f32_f16 v150, v146
    v_sub_f32 v147, v151, v147
    v_sub_f32 v148, v152, v148
    v_sub_f32 v149, v153, v149
    v_sub_f32 v150, v154, v150
    v_cvt_f16_f32 v147, v147
    v_cvt_f16_f32 v148, v148
    v_cvt_f16_f32 v149, v149
    v_cvt_f16_f32 v150, v150
    v_pack_b32_f16 v143, v143, v147
    v_pack_b32_f16 v144, v144, v148
    v_pack_b32_f16 v145, v145, v149
    v_pack_b32_f16 v146, v146, v150
    ds_write_b32 v142, v143 offset:2048
    ds_write_b32 v142, v144 offset:2112
    ds_write_b32 v142, v145 offset:2176
    ds_write_b32 v142, v146 offset:2240
    v_mov_b32 v59, s56
    ds_write_b32 v59, v135 offset:3068
    s_waitcnt lgkmcnt(0)
    v_mov_b32 v7, 1
    ds_write_b32 v5, v7
    s_nop 0
K23_KG_B:
    s_lshr_b32 s50, s32, 1
    s_mul_i32 s50, s50, 8512
    s_add_u32 s50, s50, 135168
    s_lshr_b32 s51, s32, 1
    s_mul_i32 s51, s51, 5120
    s_add_u32 s51, s51, 152192
    v_mov_b32 v57, s50
    ds_read_b32 v56, v57 offset:3068
    v_lshlrev_b32 v59, 4, v1
    s_lshl_b32 s34, s36, 10
    v_add_u32 v59, s34, v59
    s_sub_u32 s52, s50, 68096
    s_mov_b32 s53, 0x05040100
    v_add_u32 v88, 0, v59
    v_add_u32 v89, 1, v59
    v_add_u32 v90, 2, v59
    v_add_u32 v91, 3, v59
    v_cvt_f32_u32 v84, v88
    v_cvt_f32_u32 v85, v89
    v_cvt_f32_u32 v86, v90
    v_cvt_f32_u32 v87, v91
    v_cvt_pk_bf16_f32 v84, v84, v84
    v_cvt_pk_bf16_f32 v85, v85, v85
    v_cvt_pk_bf16_f32 v86, v86, v86
    v_cvt_pk_bf16_f32 v87, v87, v87
    v_and_b32 v84, 0xffff, v84
    v_and_b32 v85, 0xffff, v85
    v_and_b32 v86, 0xffff, v86
    v_and_b32 v87, 0xffff, v87
    v_lshl_add_u32 v84, v84, 2, s52
    v_lshl_add_u32 v92, v88, 2, s50
    v_lshl_add_u32 v85, v85, 2, s52
    v_lshl_add_u32 v93, v89, 2, s50
    v_lshl_add_u32 v86, v86, 2, s52
    v_lshl_add_u32 v94, v90, 2, s50
    v_lshl_add_u32 v87, v87, 2, s52
    v_lshl_add_u32 v95, v91, 2, s50
    v_cmp_gt_u32 vcc, 128, v88
    s_nop 1
    v_cndmask_b32 v84, v84, v92, vcc
    v_cmp_gt_u32 vcc, 128, v89
    s_nop 1
    v_cndmask_b32 v85, v85, v93, vcc
    v_cmp_gt_u32 vcc, 128, v90
    s_nop 1
    v_cndmask_b32 v86, v86, v94, vcc
    v_cmp_gt_u32 vcc, 128, v91
    s_nop 1
    v_cndmask_b32 v87, v87, v95, vcc
    ds_read_b32 v67, v84
    ds_read_b32 v66, v85
    ds_read_b32 v65, v86
    ds_read_b32 v64, v87
    v_add_u32 v88, 4, v59
    v_add_u32 v89, 5, v59
    v_add_u32 v90, 6, v59
    v_add_u32 v91, 7, v59
    v_cvt_f32_u32 v84, v88
    v_cvt_f32_u32 v85, v89
    v_cvt_f32_u32 v86, v90
    v_cvt_f32_u32 v87, v91
    v_cvt_pk_bf16_f32 v84, v84, v84
    v_cvt_pk_bf16_f32 v85, v85, v85
    v_cvt_pk_bf16_f32 v86, v86, v86
    v_cvt_pk_bf16_f32 v87, v87, v87
    v_and_b32 v84, 0xffff, v84
    v_and_b32 v85, 0xffff, v85
    v_and_b32 v86, 0xffff, v86
    v_and_b32 v87, 0xffff, v87
    v_lshl_add_u32 v84, v84, 2, s52
    v_lshl_add_u32 v92, v88, 2, s50
    v_lshl_add_u32 v85, v85, 2, s52
    v_lshl_add_u32 v93, v89, 2, s50
    v_lshl_add_u32 v86, v86, 2, s52
    v_lshl_add_u32 v94, v90, 2, s50
    v_lshl_add_u32 v87, v87, 2, s52
    v_lshl_add_u32 v95, v91, 2, s50
    v_cmp_gt_u32 vcc, 128, v88
    s_nop 1
    v_cndmask_b32 v84, v84, v92, vcc
    v_cmp_gt_u32 vcc, 128, v89
    s_nop 1
    v_cndmask_b32 v85, v85, v93, vcc
    v_cmp_gt_u32 vcc, 128, v90
    s_nop 1
    v_cndmask_b32 v86, v86, v94, vcc
    v_cmp_gt_u32 vcc, 128, v91
    s_nop 1
    v_cndmask_b32 v87, v87, v95, vcc
    ds_read_b32 v63, v84
    ds_read_b32 v62, v85
    ds_read_b32 v61, v86
    ds_read_b32 v60, v87
    v_add_u32 v88, 8, v59
    v_add_u32 v89, 9, v59
    v_add_u32 v90, 10, v59
    v_add_u32 v91, 11, v59
    v_cvt_f32_u32 v84, v88
    v_cvt_f32_u32 v85, v89
    v_cvt_f32_u32 v86, v90
    v_cvt_f32_u32 v87, v91
    v_cvt_pk_bf16_f32 v84, v84, v84
    v_cvt_pk_bf16_f32 v85, v85, v85
    v_cvt_pk_bf16_f32 v86, v86, v86
    v_cvt_pk_bf16_f32 v87, v87, v87
    v_and_b32 v84, 0xffff, v84
    v_and_b32 v85, 0xffff, v85
    v_and_b32 v86, 0xffff, v86
    v_and_b32 v87, 0xffff, v87
    v_lshl_add_u32 v84, v84, 2, s52
    v_lshl_add_u32 v92, v88, 2, s50
    v_lshl_add_u32 v85, v85, 2, s52
    v_lshl_add_u32 v93, v89, 2, s50
    v_lshl_add_u32 v86, v86, 2, s52
    v_lshl_add_u32 v94, v90, 2, s50
    v_lshl_add_u32 v87, v87, 2, s52
    v_lshl_add_u32 v95, v91, 2, s50
    v_cmp_gt_u32 vcc, 128, v88
    s_nop 1
    v_cndmask_b32 v84, v84, v92, vcc
    v_cmp_gt_u32 vcc, 128, v89
    s_nop 1
    v_cndmask_b32 v85, v85, v93, vcc
    v_cmp_gt_u32 vcc, 128, v90
    s_nop 1
    v_cndmask_b32 v86, v86, v94, vcc
    v_cmp_gt_u32 vcc, 128, v91
    s_nop 1
    v_cndmask_b32 v87, v87, v95, vcc
    ds_read_b32 v75, v84
    ds_read_b32 v74, v85
    ds_read_b32 v73, v86
    ds_read_b32 v72, v87
    v_add_u32 v88, 12, v59
    v_add_u32 v89, 13, v59
    v_add_u32 v90, 14, v59
    v_add_u32 v91, 15, v59
    v_cvt_f32_u32 v84, v88
    v_cvt_f32_u32 v85, v89
    v_cvt_f32_u32 v86, v90
    v_cvt_f32_u32 v87, v91
    v_cvt_pk_bf16_f32 v84, v84, v84
    v_cvt_pk_bf16_f32 v85, v85, v85
    v_cvt_pk_bf16_f32 v86, v86, v86
    v_cvt_pk_bf16_f32 v87, v87, v87
    v_and_b32 v84, 0xffff, v84
    v_and_b32 v85, 0xffff, v85
    v_and_b32 v86, 0xffff, v86
    v_and_b32 v87, 0xffff, v87
    v_lshl_add_u32 v84, v84, 2, s52
    v_lshl_add_u32 v92, v88, 2, s50
    v_lshl_add_u32 v85, v85, 2, s52
    v_lshl_add_u32 v93, v89, 2, s50
    v_lshl_add_u32 v86, v86, 2, s52
    v_lshl_add_u32 v94, v90, 2, s50
    v_lshl_add_u32 v87, v87, 2, s52
    v_lshl_add_u32 v95, v91, 2, s50
    v_cmp_gt_u32 vcc, 128, v88
    s_nop 1
    v_cndmask_b32 v84, v84, v92, vcc
    v_cmp_gt_u32 vcc, 128, v89
    s_nop 1
    v_cndmask_b32 v85, v85, v93, vcc
    v_cmp_gt_u32 vcc, 128, v90
    s_nop 1
    v_cndmask_b32 v86, v86, v94, vcc
    v_cmp_gt_u32 vcc, 128, v91
    s_nop 1
    v_cndmask_b32 v87, v87, v95, vcc
    ds_read_b32 v71, v84
    ds_read_b32 v70, v85
    ds_read_b32 v69, v86
    ds_read_b32 v68, v87
    v_mov_b32 v96, 0
    v_mov_b32 v97, 0
    v_mov_b32 v98, 0
    v_mov_b32 v99, 0
    s_mov_b32 s54, 0x78
    v_bfe_u32 v100, v59, 7, 2
    v_lshlrev_b32 v100, 1, v100
    v_lshrrev_b32 v100, v100, s54
    v_and_b32 v100, 3, v100
    v_bfe_u32 v101, v59, 3, 2
    v_xor_b32 v100, v100, v101
    v_xor_b32 v101, 1, v100
    v_lshrrev_b32 v92, 5, v59
    v_lshlrev_b32 v92, 6, v92
    v_add_u32 v92, s51, v92
    v_lshl_add_u32 v100, v100, 4, v92
    v_lshl_add_u32 v101, v101, 4, v92
    v_and_b32 v102, 31, v1
    v_lshlrev_b32 v102, 4, v102
    s_lshl_b32 s34, s36, 9
    s_add_u32 s34, s34, s51
    v_add_u32 v102, s34, v102
    ds_write_b128 v102, v[96:99]
    s_waitcnt lgkmcnt(1)
    v_perm_b32 v76, v61, v60, s53
    v_perm_b32 v77, v63, v62, s53
    v_perm_b32 v78, v65, v64, s53
    v_perm_b32 v79, v67, v66, s53
    v_perm_b32 v80, v69, v68, s53
    v_perm_b32 v81, v71, v70, s53
    v_perm_b32 v82, v73, v72, s53
    v_perm_b32 v83, v75, v74, s53
    ds_write_b128 v100, v[76:79] offset:1024
    ds_write_b128 v101, v[80:83] offset:1024
    s_waitcnt lgkmcnt(0)
    v_mov_b32 v7, 2
    ds_write_b32 v5, v7
    s_nop 0
SPIN_10:
    ds_read_b32 v7, v6
    s_waitcnt lgkmcnt(0)
    v_readfirstlane_b32 s37, v7
    s_cmp_lt_u32 s37, 2
    s_cbranch_scc1 SPIN_10
    s_setprio 3
    s_cmp_lt_u32 s32, 2
    s_cselect_b32 s52, 24, 28
    s_cselect_b32 s53, 90112, 0
    v_mov_b32 v59, 162464
    s_nop 1
WG_11:
    s_sleep 1
    ds_read_b32 v7, v59
    s_waitcnt lgkmcnt(0)
    v_readfirstlane_b32 s37, v7
    s_cmp_lt_u32 s37, s52
    s_cbranch_scc1 WG_11
    s_mul_i32 s54, s36, 17024
    s_add_u32 s54, s54, s53
    v_add_u32 v60, s54, v15
    s_waitcnt vmcnt(0)
    v_alignbit_b32 v64, v17, v16, 16
    v_mov_b32 v68, v17
    v_alignbit_b32 v72, v18, v17, 16
    v_alignbit_b32 v65, v18, v17, 16
    v_mov_b32 v69, v18
    v_alignbit_b32 v73, v19, v18, 16
    v_alignbit_b32 v66, v19, v18, 16
    v_mov_b32 v70, v19
    v_alignbit_b32 v74, v20, v19, 16
    v_alignbit_b32 v67, v20, v19, 16
    v_mov_b32 v71, v20
    v_alignbit_b32 v75, v21, v20, 16
    ds_write_b128 v60, v[16:19] offset:0
    ds_write_b128 v60, v[64:67] offset:4256
    ds_write_b128 v60, v[68:71] offset:8512
    ds_write_b128 v60, v[72:75] offset:12768
    v_alignbit_b32 v64, v25, v24, 16
    v_mov_b32 v68, v25
    v_alignbit_b32 v72, v26, v25, 16
    v_alignbit_b32 v65, v26, v25, 16
    v_mov_b32 v69, v26
    v_alignbit_b32 v73, v27, v26, 16
    v_alignbit_b32 v66, v27, v26, 16
    v_mov_b32 v70, v27
    v_alignbit_b32 v74, v28, v27, 16
    v_alignbit_b32 v67, v28, v27, 16
    v_mov_b32 v71, v28
    v_alignbit_b32 v75, v29, v28, 16
    ds_write_b128 v60, v[24:27] offset:1024
    ds_write_b128 v60, v[64:67] offset:5280
    ds_write_b128 v60, v[68:71] offset:9536
    ds_write_b128 v60, v[72:75] offset:13792
    v_alignbit_b32 v64, v33, v32, 16
    v_mov_b32 v68, v33
    v_alignbit_b32 v72, v34, v33, 16
    v_alignbit_b32 v65, v34, v33, 16
    v_mov_b32 v69, v34
    v_alignbit_b32 v73, v35, v34, 16
    v_alignbit_b32 v66, v35, v34, 16
    v_mov_b32 v70, v35
    v_alignbit_b32 v74, v36, v35, 16
    v_alignbit_b32 v67, v36, v35, 16
    v_mov_b32 v71, v36
    v_alignbit_b32 v75, v37, v36, 16
    ds_write_b128 v60, v[32:35] offset:2048
    ds_write_b128 v60, v[64:67] offset:6304
    ds_write_b128 v60, v[68:71] offset:10560
    ds_write_b128 v60, v[72:75] offset:14816
    v_alignbit_b32 v64, v41, v40, 16
    v_mov_b32 v68, v41
    v_alignbit_b32 v72, v42, v41, 16
    v_alignbit_b32 v65, v42, v41, 16
    v_mov_b32 v69, v42
    v_alignbit_b32 v73, v43, v42, 16
    v_alignbit_b32 v66, v43, v42, 16
    v_mov_b32 v70, v43
    v_alignbit_b32 v74, v44, v43, 16
    v_alignbit_b32 v67, v44, v43, 16
    v_mov_b32 v71, v44
    v_alignbit_b32 v75, v45, v44, 16
    ds_write_b128 v60, v[40:43] offset:3072
    ds_write_b128 v60, v[64:67] offset:7328
    ds_write_b128 v60, v[68:71] offset:11584
    ds_write_b128 v60, v[72:75] offset:15840
    v_cmp_gt_u32 vcc, 4, v1
    s_and_saveexec_b64 s[56:57], vcc
    v_alignbit_b32 v64, v49, v48, 16
    v_mov_b32 v68, v49
    v_alignbit_b32 v72, v50, v49, 16
    v_alignbit_b32 v65, v50, v49, 16
    v_mov_b32 v69, v50
    v_alignbit_b32 v73, v51, v50, 16
    v_alignbit_b32 v66, v51, v50, 16
    v_mov_b32 v70, v51
    v_alignbit_b32 v74, v52, v51, 16
    v_alignbit_b32 v67, v52, v51, 16
    v_mov_b32 v71, v52
    v_alignbit_b32 v75, v53, v52, 16
    ds_write_b128 v60, v[48:51] offset:4096
    ds_write_b128 v60, v[64:67] offset:8352
    ds_write_b128 v60, v[68:71] offset:12608
    ds_write_b128 v60, v[72:75] offset:16864
    s_mov_b64 exec, s[56:57]
    s_waitcnt lgkmcnt(0)
    v_mov_b32 v7, 3
    ds_write_b32 v5, v7
    s_nop 0
SPIN_12:
    ds_read_b32 v7, v6
    s_waitcnt lgkmcnt(0)
    v_readfirstlane_b32 s37, v7
    s_cmp_lt_u32 s37, 3
    s_cbranch_scc1 SPIN_12
    s_add_u32 s56, s30, 18874368
    s_addc_u32 s57, s31, 0
    s_and_b32 s57, s57, 0xffff
    s_mov_b32 s58, 2097152
    s_mov_b32 s59, 0x00020000
    v_add_u32 v57, 1, v3
    v_and_b32 v58, 7, v57
    v_mul_u32_u24 v60, 4256, v58
    v_lshrrev_b32 v57, 3, v57
    v_sub_u32 v57, v57, v4
    v_add_u32 v57, 3, v57
    v_lshl_add_u32 v60, v57, 4, v60
    s_lshl_b32 s60, s36, 5
    s_add_u32 s34, s53, s60
    v_add_u32 v60, s34, v60
    s_mov_b32 s61, 0x78
    s_mov_b32 s64, s24
    s_and_b32 s65, s25, 0xffff
    s_mov_b32 s66, 1835008
    s_mov_b32 s67, 0x00020000
    s_lshr_b32 s68, s33, 3
    s_lshl_b32 s68, s68, 2
    s_add_u32 s68, s68, s32
    s_mul_i32 s68, s68, 14336
    v_add_u32 v64, 16, v3
    v_bfe_u32 v65, v64, 2, 2
    v_lshlrev_b32 v65, 1, v65
    v_lshrrev_b32 v65, v65, s61
    v_and_b32 v65, 3, v65
    v_xor_b32 v65, v65, v4
    v_lshlrev_b32 v64, 6, v64
    v_lshl_add_u32 v61, v65, 4, v64
    v_add_u32 v61, s51, v61
    ds_read_b128 v[84:87], v61 offset:0
    ds_read_b128 v[88:91], v61 offset:1024
    ds_read_b128 v[92:95], v61 offset:2048
    ds_read_b128 v[96:99], v61 offset:3072
    ds_read_b128 v[132:135], v60 offset:0
    ds_read_b128 v[136:139], v60 offset:1024
    ds_read_b128 v[140:143], v60 offset:2048
    ds_read_b128 v[144:147], v60 offset:3072
    v_add_u32 v64, 15, v3
    v_bfe_u32 v65, v64, 2, 2
    v_lshlrev_b32 v65, 1, v65
    v_lshrrev_b32 v65, v65, s61
    v_and_b32 v65, 3, v65
    v_xor_b32 v65, v65, v4
    v_lshlrev_b32 v64, 6, v64
    v_lshl_add_u32 v62, v65, 4, v64
    v_add_u32 v62, s51, v62
    ds_read_b128 v[100:103], v62 offset:0
    ds_read_b128 v[104:107], v62 offset:1024
    ds_read_b128 v[108:111], v62 offset:2048
    ds_read_b128 v[112:115], v62 offset:3072
    ds_read_b128 v[148:151], v60 offset:64
    ds_read_b128 v[152:155], v60 offset:1088
    ds_read_b128 v[156:159], v60 offset:2112
    ds_read_b128 v[160:163], v60 offset:3136
    s_waitcnt lgkmcnt(8)
    v_add_u32 v64, 14, v3
    v_bfe_u32 v65, v64, 2, 2
    v_lshlrev_b32 v65, 1, v65
    v_lshrrev_b32 v65, v65, s61
    v_and_b32 v65, 3, v65
    v_xor_b32 v65, v65, v4
    v_lshlrev_b32 v64, 6, v64
    v_lshl_add_u32 v63, v65, 4, v64
    v_add_u32 v63, s51, v63
    ds_read_b128 v[116:119], v63 offset:0
    ds_read_b128 v[120:123], v63 offset:1024
    ds_read_b128 v[124:127], v63 offset:2048
    ds_read_b128 v[128:131], v63 offset:3072
    ds_read_b128 v[164:167], v60 offset:128
    ds_read_b128 v[168:171], v60 offset:1152
    ds_read_b128 v[172:175], v60 offset:2176
    ds_read_b128 v[176:179], v60 offset:3200
    v_mfma_f32_16x16x32_f16 v[68:71], v[132:135], v[84:87], 0
    v_mfma_f32_16x16x32_f16 v[72:75], v[132:135], v[88:91], 0
    v_mfma_f32_16x16x32_f16 v[76:79], v[132:135], v[92:95], 0
    v_mfma_f32_16x16x32_f16 v[80:83], v[132:135], v[96:99], 0
    v_mfma_f32_16x16x32_f16 v[72:75], v[136:139], v[84:87], v[72:75]
    v_mfma_f32_16x16x32_f16 v[76:79], v[136:139], v[88:91], v[76:79]
    v_mfma_f32_16x16x32_f16 v[80:83], v[136:139], v[92:95], v[80:83]
    v_mfma_f32_16x16x32_f16 v[76:79], v[140:143], v[84:87], v[76:79]
    v_mfma_f32_16x16x32_f16 v[80:83], v[140:143], v[88:91], v[80:83]
    v_mfma_f32_16x16x32_f16 v[80:83], v[144:147], v[84:87], v[80:83]
    buffer_load_dwordx4 v[180:183], v15, s[64:67], s68 offen
    s_add_u32 s68, s68, 1024
    s_waitcnt lgkmcnt(8)
    v_add_u32 v64, 13, v3
    v_bfe_u32 v65, v64, 2, 2
    v_lshlrev_b32 v65, 1, v65
    v_lshrrev_b32 v65, v65, s61
    v_and_b32 v65, 3, v65
    v_xor_b32 v65, v65, v4
    v_lshlrev_b32 v64, 6, v64
    v_lshl_add_u32 v61, v65, 4, v64
    v_add_u32 v61, s51, v61
    ds_read_b128 v[84:87], v61 offset:0
    ds_read_b128 v[88:91], v61 offset:1024
    ds_read_b128 v[92:95], v61 offset:2048
    ds_read_b128 v[96:99], v61 offset:3072
    ds_read_b128 v[132:135], v60 offset:192
    ds_read_b128 v[136:139], v60 offset:1216
    ds_read_b128 v[140:143], v60 offset:2240
    ds_read_b128 v[144:147], v60 offset:3264
    v_mfma_f32_16x16x32_f16 v[68:71], v[148:151], v[100:103], v[68:71]
    v_mfma_f32_16x16x32_f16 v[72:75], v[148:151], v[104:107], v[72:75]
    v_mfma_f32_16x16x32_f16 v[76:79], v[148:151], v[108:111], v[76:79]
    v_mfma_f32_16x16x32_f16 v[80:83], v[148:151], v[112:115], v[80:83]
    v_mfma_f32_16x16x32_f16 v[72:75], v[152:155], v[100:103], v[72:75]
    v_mfma_f32_16x16x32_f16 v[76:79], v[152:155], v[104:107], v[76:79]
    v_mfma_f32_16x16x32_f16 v[80:83], v[152:155], v[108:111], v[80:83]
    v_mfma_f32_16x16x32_f16 v[76:79], v[156:159], v[100:103], v[76:79]
    v_mfma_f32_16x16x32_f16 v[80:83], v[156:159], v[104:107], v[80:83]
    v_mfma_f32_16x16x32_f16 v[80:83], v[160:163], v[100:103], v[80:83]
    buffer_load_dwordx4 v[180:183], v15, s[64:67], s68 offen
    s_add_u32 s68, s68, 1024
    s_waitcnt lgkmcnt(8)
    v_add_u32 v64, 12, v3
    v_bfe_u32 v65, v64, 2, 2
    v_lshlrev_b32 v65, 1, v65
    v_lshrrev_b32 v65, v65, s61
    v_and_b32 v65, 3, v65
    v_xor_b32 v65, v65, v4
    v_lshlrev_b32 v64, 6, v64
    v_lshl_add_u32 v62, v65, 4, v64
    v_add_u32 v62, s51, v62
    ds_read_b128 v[100:103], v62 offset:0
    ds_read_b128 v[104:107], v62 offset:1024
    ds_read_b128 v[108:111], v62 offset:2048
    ds_read_b128 v[112:115], v62 offset:3072
    ds_read_b128 v[148:151], v60 offset:256
    ds_read_b128 v[152:155], v60 offset:1280
    ds_read_b128 v[156:159], v60 offset:2304
    ds_read_b128 v[160:163], v60 offset:3328
    v_mfma_f32_16x16x32_f16 v[68:71], v[164:167], v[116:119], v[68:71]
    v_mfma_f32_16x16x32_f16 v[72:75], v[164:167], v[120:123], v[72:75]
    v_mfma_f32_16x16x32_f16 v[76:79], v[164:167], v[124:127], v[76:79]
    v_mfma_f32_16x16x32_f16 v[80:83], v[164:167], v[128:131], v[80:83]
    v_mfma_f32_16x16x32_f16 v[72:75], v[168:171], v[116:119], v[72:75]
    v_mfma_f32_16x16x32_f16 v[76:79], v[168:171], v[120:123], v[76:79]
    v_mfma_f32_16x16x32_f16 v[80:83], v[168:171], v[124:127], v[80:83]
    v_mfma_f32_16x16x32_f16 v[76:79], v[172:175], v[116:119], v[76:79]
    v_mfma_f32_16x16x32_f16 v[80:83], v[172:175], v[120:123], v[80:83]
    v_mfma_f32_16x16x32_f16 v[80:83], v[176:179], v[116:119], v[80:83]
    buffer_load_dwordx4 v[180:183], v15, s[64:67], s68 offen
    s_add_u32 s68, s68, 1024
    s_waitcnt lgkmcnt(8)
    v_add_u32 v64, 11, v3
    v_bfe_u32 v65, v64, 2, 2
    v_lshlrev_b32 v65, 1, v65
    v_lshrrev_b32 v65, v65, s61
    v_and_b32 v65, 3, v65
    v_xor_b32 v65, v65, v4
    v_lshlrev_b32 v64, 6, v64
    v_lshl_add_u32 v63, v65, 4, v64
    v_add_u32 v63, s51, v63
    ds_read_b128 v[116:119], v63 offset:0
    ds_read_b128 v[120:123], v63 offset:1024
    ds_read_b128 v[124:127], v63 offset:2048
    ds_read_b128 v[128:131], v63 offset:3072
    ds_read_b128 v[164:167], v60 offset:320
    ds_read_b128 v[168:171], v60 offset:1344
    ds_read_b128 v[172:175], v60 offset:2368
    ds_read_b128 v[176:179], v60 offset:3392
    v_mfma_f32_16x16x32_f16 v[68:71], v[132:135], v[84:87], v[68:71]
    v_mfma_f32_16x16x32_f16 v[72:75], v[132:135], v[88:91], v[72:75]
    v_mfma_f32_16x16x32_f16 v[76:79], v[132:135], v[92:95], v[76:79]
    v_mfma_f32_16x16x32_f16 v[80:83], v[132:135], v[96:99], v[80:83]
    v_mfma_f32_16x16x32_f16 v[72:75], v[136:139], v[84:87], v[72:75]
    v_mfma_f32_16x16x32_f16 v[76:79], v[136:139], v[88:91], v[76:79]
    v_mfma_f32_16x16x32_f16 v[80:83], v[136:139], v[92:95], v[80:83]
    v_mfma_f32_16x16x32_f16 v[76:79], v[140:143], v[84:87], v[76:79]
    v_mfma_f32_16x16x32_f16 v[80:83], v[140:143], v[88:91], v[80:83]
    v_mfma_f32_16x16x32_f16 v[80:83], v[144:147], v[84:87], v[80:83]
    buffer_load_dwordx4 v[180:183], v15, s[64:67], s68 offen
    s_add_u32 s68, s68, 1024
    s_waitcnt lgkmcnt(8)
    v_add_u32 v64, 10, v3
    v_bfe_u32 v65, v64, 2, 2
    v_lshlrev_b32 v65, 1, v65
    v_lshrrev_b32 v65, v65, s61
    v_and_b32 v65, 3, v65
    v_xor_b32 v65, v65, v4
    v_lshlrev_b32 v64, 6, v64
    v_lshl_add_u32 v61, v65, 4, v64
    v_add_u32 v61, s51, v61
    ds_read_b128 v[84:87], v61 offset:0
    ds_read_b128 v[88:91], v61 offset:1024
    ds_read_b128 v[92:95], v61 offset:2048
    ds_read_b128 v[96:99], v61 offset:3072
    ds_read_b128 v[132:135], v60 offset:384
    ds_read_b128 v[136:139], v60 offset:1408
    ds_read_b128 v[140:143], v60 offset:2432
    ds_read_b128 v[144:147], v60 offset:3456
    v_mfma_f32_16x16x32_f16 v[68:71], v[148:151], v[100:103], v[68:71]
    v_mfma_f32_16x16x32_f16 v[72:75], v[148:151], v[104:107], v[72:75]
    v_mfma_f32_16x16x32_f16 v[76:79], v[148:151], v[108:111], v[76:79]
    v_mfma_f32_16x16x32_f16 v[80:83], v[148:151], v[112:115], v[80:83]
    v_mfma_f32_16x16x32_f16 v[72:75], v[152:155], v[100:103], v[72:75]
    v_mfma_f32_16x16x32_f16 v[76:79], v[152:155], v[104:107], v[76:79]
    v_mfma_f32_16x16x32_f16 v[80:83], v[152:155], v[108:111], v[80:83]
    v_mfma_f32_16x16x32_f16 v[76:79], v[156:159], v[100:103], v[76:79]
    v_mfma_f32_16x16x32_f16 v[80:83], v[156:159], v[104:107], v[80:83]
    v_mfma_f32_16x16x32_f16 v[80:83], v[160:163], v[100:103], v[80:83]
    buffer_load_dwordx4 v[180:183], v15, s[64:67], s68 offen
    s_add_u32 s68, s68, 1024
    s_waitcnt lgkmcnt(8)
    v_add_u32 v64, 9, v3
    v_bfe_u32 v65, v64, 2, 2
    v_lshlrev_b32 v65, 1, v65
    v_lshrrev_b32 v65, v65, s61
    v_and_b32 v65, 3, v65
    v_xor_b32 v65, v65, v4
    v_lshlrev_b32 v64, 6, v64
    v_lshl_add_u32 v62, v65, 4, v64
    v_add_u32 v62, s51, v62
    ds_read_b128 v[100:103], v62 offset:0
    ds_read_b128 v[104:107], v62 offset:1024
    ds_read_b128 v[108:111], v62 offset:2048
    ds_read_b128 v[112:115], v62 offset:3072
    ds_read_b128 v[148:151], v60 offset:448
    ds_read_b128 v[152:155], v60 offset:1472
    ds_read_b128 v[156:159], v60 offset:2496
    ds_read_b128 v[160:163], v60 offset:3520
    v_mfma_f32_16x16x32_f16 v[68:71], v[164:167], v[116:119], v[68:71]
    v_mfma_f32_16x16x32_f16 v[72:75], v[164:167], v[120:123], v[72:75]
    v_mfma_f32_16x16x32_f16 v[76:79], v[164:167], v[124:127], v[76:79]
    v_mfma_f32_16x16x32_f16 v[80:83], v[164:167], v[128:131], v[80:83]
    v_mfma_f32_16x16x32_f16 v[72:75], v[168:171], v[116:119], v[72:75]
    v_mfma_f32_16x16x32_f16 v[76:79], v[168:171], v[120:123], v[76:79]
    v_mfma_f32_16x16x32_f16 v[80:83], v[168:171], v[124:127], v[80:83]
    v_mfma_f32_16x16x32_f16 v[76:79], v[172:175], v[116:119], v[76:79]
    v_mfma_f32_16x16x32_f16 v[80:83], v[172:175], v[120:123], v[80:83]
    v_mfma_f32_16x16x32_f16 v[80:83], v[176:179], v[116:119], v[80:83]
    buffer_load_dwordx4 v[180:183], v15, s[64:67], s68 offen
    s_add_u32 s68, s68, 1024
    s_waitcnt lgkmcnt(8)
    v_add_u32 v64, 8, v3
    v_bfe_u32 v65, v64, 2, 2
    v_lshlrev_b32 v65, 1, v65
    v_lshrrev_b32 v65, v65, s61
    v_and_b32 v65, 3, v65
    v_xor_b32 v65, v65, v4
    v_lshlrev_b32 v64, 6, v64
    v_lshl_add_u32 v63, v65, 4, v64
    v_add_u32 v63, s51, v63
    ds_read_b128 v[116:119], v63 offset:0
    ds_read_b128 v[120:123], v63 offset:1024
    ds_read_b128 v[124:127], v63 offset:2048
    ds_read_b128 v[128:131], v63 offset:3072
    ds_read_b128 v[164:167], v60 offset:512
    ds_read_b128 v[168:171], v60 offset:1536
    ds_read_b128 v[172:175], v60 offset:2560
    ds_read_b128 v[176:179], v60 offset:3584
    v_mfma_f32_16x16x32_f16 v[68:71], v[132:135], v[84:87], v[68:71]
    v_mfma_f32_16x16x32_f16 v[72:75], v[132:135], v[88:91], v[72:75]
    v_mfma_f32_16x16x32_f16 v[76:79], v[132:135], v[92:95], v[76:79]
    v_mfma_f32_16x16x32_f16 v[80:83], v[132:135], v[96:99], v[80:83]
    v_mfma_f32_16x16x32_f16 v[72:75], v[136:139], v[84:87], v[72:75]
    v_mfma_f32_16x16x32_f16 v[76:79], v[136:139], v[88:91], v[76:79]
    v_mfma_f32_16x16x32_f16 v[80:83], v[136:139], v[92:95], v[80:83]
    v_mfma_f32_16x16x32_f16 v[76:79], v[140:143], v[84:87], v[76:79]
    v_mfma_f32_16x16x32_f16 v[80:83], v[140:143], v[88:91], v[80:83]
    v_mfma_f32_16x16x32_f16 v[80:83], v[144:147], v[84:87], v[80:83]
    buffer_load_dwordx4 v[180:183], v15, s[64:67], s68 offen
    s_add_u32 s68, s68, 1024
    s_waitcnt lgkmcnt(8)
    v_add_u32 v64, 7, v3
    v_bfe_u32 v65, v64, 2, 2
    v_lshlrev_b32 v65, 1, v65
    v_lshrrev_b32 v65, v65, s61
    v_and_b32 v65, 3, v65
    v_xor_b32 v65, v65, v4
    v_lshlrev_b32 v64, 6, v64
    v_lshl_add_u32 v61, v65, 4, v64
    v_add_u32 v61, s51, v61
    ds_read_b128 v[84:87], v61 offset:0
    ds_read_b128 v[88:91], v61 offset:1024
    ds_read_b128 v[92:95], v61 offset:2048
    ds_read_b128 v[96:99], v61 offset:3072
    ds_read_b128 v[132:135], v60 offset:576
    ds_read_b128 v[136:139], v60 offset:1600
    ds_read_b128 v[140:143], v60 offset:2624
    ds_read_b128 v[144:147], v60 offset:3648
    v_mfma_f32_16x16x32_f16 v[68:71], v[148:151], v[100:103], v[68:71]
    v_mfma_f32_16x16x32_f16 v[72:75], v[148:151], v[104:107], v[72:75]
    v_mfma_f32_16x16x32_f16 v[76:79], v[148:151], v[108:111], v[76:79]
    v_mfma_f32_16x16x32_f16 v[80:83], v[148:151], v[112:115], v[80:83]
    v_mfma_f32_16x16x32_f16 v[72:75], v[152:155], v[100:103], v[72:75]
    v_mfma_f32_16x16x32_f16 v[76:79], v[152:155], v[104:107], v[76:79]
    v_mfma_f32_16x16x32_f16 v[80:83], v[152:155], v[108:111], v[80:83]
    v_mfma_f32_16x16x32_f16 v[76:79], v[156:159], v[100:103], v[76:79]
    v_mfma_f32_16x16x32_f16 v[80:83], v[156:159], v[104:107], v[80:83]
    v_mfma_f32_16x16x32_f16 v[80:83], v[160:163], v[100:103], v[80:83]
    buffer_load_dwordx4 v[180:183], v15, s[64:67], s68 offen
    s_add_u32 s68, s68, 1024
    s_waitcnt lgkmcnt(8)
    v_add_u32 v64, 6, v3
    v_bfe_u32 v65, v64, 2, 2
    v_lshlrev_b32 v65, 1, v65
    v_lshrrev_b32 v65, v65, s61
    v_and_b32 v65, 3, v65
    v_xor_b32 v65, v65, v4
    v_lshlrev_b32 v64, 6, v64
    v_lshl_add_u32 v62, v65, 4, v64
    v_add_u32 v62, s51, v62
    ds_read_b128 v[100:103], v62 offset:0
    ds_read_b128 v[104:107], v62 offset:1024
    ds_read_b128 v[108:111], v62 offset:2048
    ds_read_b128 v[112:115], v62 offset:3072
    ds_read_b128 v[148:151], v60 offset:640
    ds_read_b128 v[152:155], v60 offset:1664
    ds_read_b128 v[156:159], v60 offset:2688
    ds_read_b128 v[160:163], v60 offset:3712
    v_mfma_f32_16x16x32_f16 v[68:71], v[164:167], v[116:119], v[68:71]
    v_mfma_f32_16x16x32_f16 v[72:75], v[164:167], v[120:123], v[72:75]
    v_mfma_f32_16x16x32_f16 v[76:79], v[164:167], v[124:127], v[76:79]
    v_mfma_f32_16x16x32_f16 v[80:83], v[164:167], v[128:131], v[80:83]
    v_mfma_f32_16x16x32_f16 v[72:75], v[168:171], v[116:119], v[72:75]
    v_mfma_f32_16x16x32_f16 v[76:79], v[168:171], v[120:123], v[76:79]
    v_mfma_f32_16x16x32_f16 v[80:83], v[168:171], v[124:127], v[80:83]
    v_mfma_f32_16x16x32_f16 v[76:79], v[172:175], v[116:119], v[76:79]
    v_mfma_f32_16x16x32_f16 v[80:83], v[172:175], v[120:123], v[80:83]
    v_mfma_f32_16x16x32_f16 v[80:83], v[176:179], v[116:119], v[80:83]
    buffer_load_dwordx4 v[180:183], v15, s[64:67], s68 offen
    s_add_u32 s68, s68, 1024
    s_waitcnt lgkmcnt(8)
    v_add_u32 v64, 5, v3
    v_bfe_u32 v65, v64, 2, 2
    v_lshlrev_b32 v65, 1, v65
    v_lshrrev_b32 v65, v65, s61
    v_and_b32 v65, 3, v65
    v_xor_b32 v65, v65, v4
    v_lshlrev_b32 v64, 6, v64
    v_lshl_add_u32 v63, v65, 4, v64
    v_add_u32 v63, s51, v63
    ds_read_b128 v[116:119], v63 offset:0
    ds_read_b128 v[120:123], v63 offset:1024
    ds_read_b128 v[124:127], v63 offset:2048
    ds_read_b128 v[128:131], v63 offset:3072
    ds_read_b128 v[164:167], v60 offset:704
    ds_read_b128 v[168:171], v60 offset:1728
    ds_read_b128 v[172:175], v60 offset:2752
    ds_read_b128 v[176:179], v60 offset:3776
    v_mfma_f32_16x16x32_f16 v[68:71], v[132:135], v[84:87], v[68:71]
    v_mfma_f32_16x16x32_f16 v[72:75], v[132:135], v[88:91], v[72:75]
    v_mfma_f32_16x16x32_f16 v[76:79], v[132:135], v[92:95], v[76:79]
    v_mfma_f32_16x16x32_f16 v[80:83], v[132:135], v[96:99], v[80:83]
    v_mfma_f32_16x16x32_f16 v[72:75], v[136:139], v[84:87], v[72:75]
    v_mfma_f32_16x16x32_f16 v[76:79], v[136:139], v[88:91], v[76:79]
    v_mfma_f32_16x16x32_f16 v[80:83], v[136:139], v[92:95], v[80:83]
    v_mfma_f32_16x16x32_f16 v[76:79], v[140:143], v[84:87], v[76:79]
    v_mfma_f32_16x16x32_f16 v[80:83], v[140:143], v[88:91], v[80:83]
    v_mfma_f32_16x16x32_f16 v[80:83], v[144:147], v[84:87], v[80:83]
    buffer_load_dwordx4 v[180:183], v15, s[64:67], s68 offen
    s_add_u32 s68, s68, 1024
    s_waitcnt lgkmcnt(8)
    v_add_u32 v64, 4, v3
    v_bfe_u32 v65, v64, 2, 2
    v_lshlrev_b32 v65, 1, v65
    v_lshrrev_b32 v65, v65, s61
    v_and_b32 v65, 3, v65
    v_xor_b32 v65, v65, v4
    v_lshlrev_b32 v64, 6, v64
    v_lshl_add_u32 v61, v65, 4, v64
    v_add_u32 v61, s51, v61
    ds_read_b128 v[84:87], v61 offset:0
    ds_read_b128 v[88:91], v61 offset:1024
    ds_read_b128 v[92:95], v61 offset:2048
    ds_read_b128 v[96:99], v61 offset:3072
    ds_read_b128 v[132:135], v60 offset:768
    ds_read_b128 v[136:139], v60 offset:1792
    ds_read_b128 v[140:143], v60 offset:2816
    ds_read_b128 v[144:147], v60 offset:3840
    v_mfma_f32_16x16x32_f16 v[68:71], v[148:151], v[100:103], v[68:71]
    v_mfma_f32_16x16x32_f16 v[72:75], v[148:151], v[104:107], v[72:75]
    v_mfma_f32_16x16x32_f16 v[76:79], v[148:151], v[108:111], v[76:79]
    v_mfma_f32_16x16x32_f16 v[80:83], v[148:151], v[112:115], v[80:83]
    v_mfma_f32_16x16x32_f16 v[72:75], v[152:155], v[100:103], v[72:75]
    v_mfma_f32_16x16x32_f16 v[76:79], v[152:155], v[104:107], v[76:79]
    v_mfma_f32_16x16x32_f16 v[80:83], v[152:155], v[108:111], v[80:83]
    v_mfma_f32_16x16x32_f16 v[76:79], v[156:159], v[100:103], v[76:79]
    v_mfma_f32_16x16x32_f16 v[80:83], v[156:159], v[104:107], v[80:83]
    v_mfma_f32_16x16x32_f16 v[80:83], v[160:163], v[100:103], v[80:83]
    buffer_load_dwordx4 v[180:183], v15, s[64:67], s68 offen
    s_add_u32 s68, s68, 1024
    s_waitcnt lgkmcnt(8)
    v_add_u32 v64, 3, v3
    v_bfe_u32 v65, v64, 2, 2
    v_lshlrev_b32 v65, 1, v65
    v_lshrrev_b32 v65, v65, s61
    v_and_b32 v65, 3, v65
    v_xor_b32 v65, v65, v4
    v_lshlrev_b32 v64, 6, v64
    v_lshl_add_u32 v62, v65, 4, v64
    v_add_u32 v62, s51, v62
    ds_read_b128 v[100:103], v62 offset:0
    ds_read_b128 v[104:107], v62 offset:1024
    ds_read_b128 v[108:111], v62 offset:2048
    ds_read_b128 v[112:115], v62 offset:3072
    ds_read_b128 v[148:151], v60 offset:832
    ds_read_b128 v[152:155], v60 offset:1856
    ds_read_b128 v[156:159], v60 offset:2880
    ds_read_b128 v[160:163], v60 offset:3904
    v_mfma_f32_16x16x32_f16 v[68:71], v[164:167], v[116:119], v[68:71]
    v_mfma_f32_16x16x32_f16 v[72:75], v[164:167], v[120:123], v[72:75]
    v_mfma_f32_16x16x32_f16 v[76:79], v[164:167], v[124:127], v[76:79]
    v_mfma_f32_16x16x32_f16 v[80:83], v[164:167], v[128:131], v[80:83]
    v_mfma_f32_16x16x32_f16 v[72:75], v[168:171], v[116:119], v[72:75]
    v_mfma_f32_16x16x32_f16 v[76:79], v[168:171], v[120:123], v[76:79]
    v_mfma_f32_16x16x32_f16 v[80:83], v[168:171], v[124:127], v[80:83]
    v_mfma_f32_16x16x32_f16 v[76:79], v[172:175], v[116:119], v[76:79]
    v_mfma_f32_16x16x32_f16 v[80:83], v[172:175], v[120:123], v[80:83]
    v_mfma_f32_16x16x32_f16 v[80:83], v[176:179], v[116:119], v[80:83]
    buffer_load_dwordx4 v[180:183], v15, s[64:67], s68 offen
    s_add_u32 s68, s68, 1024
    s_waitcnt lgkmcnt(8)
    v_add_u32 v64, 2, v3
    v_bfe_u32 v65, v64, 2, 2
    v_lshlrev_b32 v65, 1, v65
    v_lshrrev_b32 v65, v65, s61
    v_and_b32 v65, 3, v65
    v_xor_b32 v65, v65, v4
    v_lshlrev_b32 v64, 6, v64
    v_lshl_add_u32 v63, v65, 4, v64
    v_add_u32 v63, s51, v63
    ds_read_b128 v[116:119], v63 offset:0
    ds_read_b128 v[120:123], v63 offset:1024
    ds_read_b128 v[124:127], v63 offset:2048
    ds_read_b128 v[128:131], v63 offset:3072
    ds_read_b128 v[164:167], v60 offset:896
    ds_read_b128 v[168:171], v60 offset:1920
    ds_read_b128 v[172:175], v60 offset:2944
    ds_read_b128 v[176:179], v60 offset:3968
    v_mfma_f32_16x16x32_f16 v[68:71], v[132:135], v[84:87], v[68:71]
    v_mfma_f32_16x16x32_f16 v[72:75], v[132:135], v[88:91], v[72:75]
    v_mfma_f32_16x16x32_f16 v[76:79], v[132:135], v[92:95], v[76:79]
    v_mfma_f32_16x16x32_f16 v[80:83], v[132:135], v[96:99], v[80:83]
    v_mfma_f32_16x16x32_f16 v[72:75], v[136:139], v[84:87], v[72:75]
    v_mfma_f32_16x16x32_f16 v[76:79], v[136:139], v[88:91], v[76:79]
    v_mfma_f32_16x16x32_f16 v[80:83], v[136:139], v[92:95], v[80:83]
    v_mfma_f32_16x16x32_f16 v[76:79], v[140:143], v[84:87], v[76:79]
    v_mfma_f32_16x16x32_f16 v[80:83], v[140:143], v[88:91], v[80:83]
    v_mfma_f32_16x16x32_f16 v[80:83], v[144:147], v[84:87], v[80:83]
    buffer_load_dwordx4 v[180:183], v15, s[64:67], s68 offen
    s_add_u32 s68, s68, 1024
    s_waitcnt lgkmcnt(8)
    v_add_u32 v64, 1, v3
    v_bfe_u32 v65, v64, 2, 2
    v_lshlrev_b32 v65, 1, v65
    v_lshrrev_b32 v65, v65, s61
    v_and_b32 v65, 3, v65
    v_xor_b32 v65, v65, v4
    v_lshlrev_b32 v64, 6, v64
    v_lshl_add_u32 v61, v65, 4, v64
    v_add_u32 v61, s51, v61
    ds_read_b128 v[84:87], v61 offset:0
    ds_read_b128 v[88:91], v61 offset:1024
    ds_read_b128 v[92:95], v61 offset:2048
    ds_read_b128 v[96:99], v61 offset:3072
    ds_read_b128 v[132:135], v60 offset:960
    ds_read_b128 v[136:139], v60 offset:1984
    ds_read_b128 v[140:143], v60 offset:3008
    ds_read_b128 v[144:147], v60 offset:4032
    v_mfma_f32_16x16x32_f16 v[68:71], v[148:151], v[100:103], v[68:71]
    v_mfma_f32_16x16x32_f16 v[72:75], v[148:151], v[104:107], v[72:75]
    v_mfma_f32_16x16x32_f16 v[76:79], v[148:151], v[108:111], v[76:79]
    v_mfma_f32_16x16x32_f16 v[80:83], v[148:151], v[112:115], v[80:83]
    v_mfma_f32_16x16x32_f16 v[72:75], v[152:155], v[100:103], v[72:75]
    v_mfma_f32_16x16x32_f16 v[76:79], v[152:155], v[104:107], v[76:79]
    v_mfma_f32_16x16x32_f16 v[80:83], v[152:155], v[108:111], v[80:83]
    v_mfma_f32_16x16x32_f16 v[76:79], v[156:159], v[100:103], v[76:79]
    v_mfma_f32_16x16x32_f16 v[80:83], v[156:159], v[104:107], v[80:83]
    v_mfma_f32_16x16x32_f16 v[80:83], v[160:163], v[100:103], v[80:83]
    buffer_load_dwordx4 v[180:183], v15, s[64:67], s68 offen
    s_add_u32 s68, s68, 1024
    s_waitcnt lgkmcnt(8)
    v_mfma_f32_16x16x32_f16 v[68:71], v[164:167], v[116:119], v[68:71]
    v_mfma_f32_16x16x32_f16 v[72:75], v[164:167], v[120:123], v[72:75]
    v_mfma_f32_16x16x32_f16 v[76:79], v[164:167], v[124:127], v[76:79]
    v_mfma_f32_16x16x32_f16 v[80:83], v[164:167], v[128:131], v[80:83]
    v_mfma_f32_16x16x32_f16 v[72:75], v[168:171], v[116:119], v[72:75]
    v_mfma_f32_16x16x32_f16 v[76:79], v[168:171], v[120:123], v[76:79]
    v_mfma_f32_16x16x32_f16 v[80:83], v[168:171], v[124:127], v[80:83]
    v_mfma_f32_16x16x32_f16 v[76:79], v[172:175], v[116:119], v[76:79]
    v_mfma_f32_16x16x32_f16 v[80:83], v[172:175], v[120:123], v[80:83]
    v_mfma_f32_16x16x32_f16 v[80:83], v[176:179], v[116:119], v[80:83]
    s_waitcnt lgkmcnt(0)
    v_mfma_f32_16x16x32_f16 v[68:71], v[132:135], v[84:87], v[68:71]
    v_mfma_f32_16x16x32_f16 v[72:75], v[132:135], v[88:91], v[72:75]
    v_mfma_f32_16x16x32_f16 v[76:79], v[132:135], v[92:95], v[76:79]
    v_mfma_f32_16x16x32_f16 v[80:83], v[132:135], v[96:99], v[80:83]
    v_mfma_f32_16x16x32_f16 v[72:75], v[136:139], v[84:87], v[72:75]
    v_mfma_f32_16x16x32_f16 v[76:79], v[136:139], v[88:91], v[76:79]
    v_mfma_f32_16x16x32_f16 v[80:83], v[136:139], v[92:95], v[80:83]
    v_mfma_f32_16x16x32_f16 v[76:79], v[140:143], v[84:87], v[76:79]
    v_mfma_f32_16x16x32_f16 v[80:83], v[140:143], v[88:91], v[80:83]
    v_mfma_f32_16x16x32_f16 v[80:83], v[144:147], v[84:87], v[80:83]
    v_lshlrev_b32 v184, 6, v3
    v_lshl_add_u32 v184, v4, 3, v184
    v_add_u32 v184, s60, v184
    s_lshl_b32 s69, s35, 12
    v_mul_f32 v68, v68, v56
    v_mul_f32 v69, v69, v56
    v_mul_f32 v70, v70, v56
    v_mul_f32 v71, v71, v56
    v_cvt_pk_bf16_f32 v186, v68, v69
    v_cvt_pk_bf16_f32 v187, v70, v71
    buffer_store_dwordx2 v[186:187], v184, s[56:59], s69 offen offset:0
    v_mul_f32 v72, v72, v56
    v_mul_f32 v73, v73, v56
    v_mul_f32 v74, v74, v56
    v_mul_f32 v75, v75, v56
    v_cvt_pk_bf16_f32 v188, v72, v73
    v_cvt_pk_bf16_f32 v189, v74, v75
    buffer_store_dwordx2 v[188:189], v184, s[56:59], s69 offen offset:1024
    v_mul_f32 v76, v76, v56
    v_mul_f32 v77, v77, v56
    v_mul_f32 v78, v78, v56
    v_mul_f32 v79, v79, v56
    v_cvt_pk_bf16_f32 v190, v76, v77
    v_cvt_pk_bf16_f32 v191, v78, v79
    buffer_store_dwordx2 v[190:191], v184, s[56:59], s69 offen offset:2048
    v_mul_f32 v80, v80, v56
    v_mul_f32 v81, v81, v56
    v_mul_f32 v82, v82, v56
    v_mul_f32 v83, v83, v56
    v_cvt_pk_bf16_f32 v192, v80, v81
    v_cvt_pk_bf16_f32 v193, v82, v83
    buffer_store_dwordx2 v[192:193], v184, s[56:59], s69 offen offset:3072
K23_END:
    s_endpgm
.globl k4_kernel
.p2align 8
.type k4_kernel,@function
k4_kernel:
    s_cmp_ge_u32 s2, 256
    s_cbranch_scc1 K4_END
    s_load_dwordx16 s[4:19], s[0:1], 0
    s_load_dwordx8 s[20:27], s[0:1], 64
    s_load_dwordx4 s[28:31], s[0:1], 96
    v_and_b32 v1, 63, v0
    v_lshrrev_b32 v2, 6, v0
    s_nop 0
    v_readfirstlane_b32 s32, v2
    s_waitcnt lgkmcnt(0)
    s_mov_b32 s33, s2
    s_add_u32 s36, s30, 10485760
    s_addc_u32 s37, s31, 0
    s_and_b32 s37, s37, 0xffff
    s_mov_b32 s38, 7340032
    s_mov_b32 s39, 0x00020000
    s_add_u32 s40, s30, 0
    s_addc_u32 s41, s31, 0
    s_and_b32 s41, s41, 0xffff
    s_mov_b32 s42, 2097152
    s_mov_b32 s43, 0x00020000
    s_add_u32 s44, s30, 18874368
    s_addc_u32 s45, s31, 0
    s_and_b32 s45, s45, 0xffff
    s_mov_b32 s46, 2097152
    s_mov_b32 s47, 0x00020000
    s_mov_b32 s48, s24
    s_and_b32 s49, s25, 0xffff
    s_mov_b32 s50, 1835008
    s_mov_b32 s51, 0x00020000
    s_mov_b32 s52, s4
    s_and_b32 s53, s5, 0xffff
    s_mov_b32 s54, 2097152
    s_mov_b32 s55, 0x00020000
    s_mov_b32 s56, s16
    s_and_b32 s57, s17, 0xffff
    s_mov_b32 s58, 1024
    s_mov_b32 s59, 0x00020000
    s_mov_b32 s60, s26
    s_and_b32 s61, s27, 0xffff
    s_mov_b32 s62, 2097152
    s_mov_b32 s63, 0x00020000
    s_and_b32 s65, s33, 7
    s_lshl_b32 s65, s65, 2
    s_lshr_b32 s64, s33, 6
    s_add_u32 s65, s65, s64
    s_lshr_b32 s66, s33, 3
    s_and_b32 s66, s66, 7
    v_and_b32 v3, 15, v1
    v_lshrrev_b32 v4, 4, v1
    v_bfe_u32 v5, v1, 1, 2
    v_and_b32 v6, 1, v4
    v_xor_b32 v5, v5, v6
    v_and_b32 v7, 1, v1
    v_lshlrev_b32 v7, 4, v7
    v_lshrrev_b32 v6, 3, v1
    v_lshl_add_u32 v7, v6, 10, v7
    v_lshl_add_u32 v8, v5, 5, v7
    v_xor_b32 v5, 2, v5
    v_lshl_add_u32 v9, v5, 5, v7
    s_mul_i32 s67, s32, 458752
    s_lshl_b32 s64, s66, 7
    s_add_u32 s67, s67, s64
    s_lshl_b32 s68, s32, 15
    v_lshrrev_b32 v5, 3, v1
    v_and_b32 v6, 7, v1
    v_xor_b32 v6, v6, v5
    v_lshlrev_b32 v6, 4, v6
    v_mul_u32_u24 v5, 3584, v5
    v_add_u32 v10, v5, v6
    s_lshl_b32 s70, s65, 6
    s_mul_i32 s71, s70, 3584
    s_mul_i32 s64, s32, 896
    s_add_u32 s71, s71, s64
    s_add_u32 s69, s67, 0
    s_add_u32 m0, s68, 0
    s_nop 0
    buffer_load_dwordx4 v8, s[48:51], s69 offen lds
    s_add_u32 s69, s71, 0
    s_add_u32 m0, s68, 8192
    s_nop 0
    buffer_load_dwordx4 v10, s[36:39], s69 offen lds
    s_add_u32 s69, s67, 8192
    s_add_u32 m0, s68, 1024
    s_nop 0
    buffer_load_dwordx4 v9, s[48:51], s69 offen lds
    s_add_u32 s69, s71, 28672
    s_add_u32 m0, s68, 9216
    s_nop 0
    buffer_load_dwordx4 v10, s[36:39], s69 offen lds
    s_add_u32 s69, s67, 16384
    s_add_u32 m0, s68, 2048
    s_nop 0
    buffer_load_dwordx4 v8, s[48:51], s69 offen lds
    s_add_u32 s69, s71, 57344
    s_add_u32 m0, s68, 10240
    s_nop 0
    buffer_load_dwordx4 v10, s[36:39], s69 offen lds
    s_add_u32 s69, s67, 24576
    s_add_u32 m0, s68, 3072
    s_nop 0
    buffer_load_dwordx4 v9, s[48:51], s69 offen lds
    s_add_u32 s69, s71, 86016
    s_add_u32 m0, s68, 11264
    s_nop 0
    buffer_load_dwordx4 v10, s[36:39], s69 offen lds
    s_add_u32 s69, s67, 32768
    s_add_u32 m0, s68, 4096
    s_nop 0
    buffer_load_dwordx4 v8, s[48:51], s69 offen lds
    s_add_u32 s69, s71, 114688
    s_add_u32 m0, s68, 12288
    s_nop 0
    buffer_load_dwordx4 v10, s[36:39], s69 offen lds
    s_add_u32 s69, s67, 40960
    s_add_u32 m0, s68, 5120
    s_nop 0
    buffer_load_dwordx4 v9, s[48:51], s69 offen lds
    s_add_u32 s69, s71, 143360
    s_add_u32 m0, s68, 13312
    s_nop 0
    buffer_load_dwordx4 v10, s[36:39], s69 offen lds
    s_add_u32 s69, s67, 49152
    s_add_u32 m0, s68, 6144
    s_nop 0
    buffer_load_dwordx4 v8, s[48:51], s69 offen lds
    s_add_u32 s69, s71, 172032
    s_add_u32 m0, s68, 14336
    s_nop 0
    buffer_load_dwordx4 v10, s[36:39], s69 offen lds
    s_add_u32 s69, s67, 57344
    s_add_u32 m0, s68, 7168
    s_nop 0
    buffer_load_dwordx4 v9, s[48:51], s69 offen lds
    s_add_u32 s69, s71, 200704
    s_add_u32 m0, s68, 15360
    s_nop 0
    buffer_load_dwordx4 v10, s[36:39], s69 offen lds
    v_lshrrev_b32 v5, 2, v0
    v_and_b32 v6, 3, v0
    v_add_u32 v7, s70, v5
    v_lshlrev_b32 v11, 10, v7
    v_lshl_add_u32 v11, v6, 5, v11
    s_lshl_b32 s64, s66, 7
    v_add_u32 v11, s64, v11
    v_lshlrev_b32 v13, 5, v6
    v_add_u32 v13, s64, v13
    s_lshl_b32 s72, s66, 6
    v_add_u32 v7, s72, v5
    v_lshlrev_b32 v12, 12, v7
    v_lshl_add_u32 v12, v6, 5, v12
    s_lshl_b32 s64, s65, 7
    v_add_u32 v12, s64, v12
    buffer_load_dwordx4 v[16:19], v11, s[52:55], 0 offen
    buffer_load_dwordx4 v[20:23], v11, s[52:55], 0 offen offset:16
    buffer_load_dwordx4 v[24:27], v11, s[40:43], 0 offen
    buffer_load_dwordx4 v[28:31], v11, s[40:43], 0 offen offset:16
    buffer_load_dwordx4 v[32:35], v13, s[56:59], 0 offen
    buffer_load_dwordx4 v[36:39], v13, s[56:59], 0 offen offset:16
    buffer_load_dwordx4 v[40:43], v12, s[44:47], 0 offen
    buffer_load_dwordx4 v[44:47], v12, s[44:47], 0 offen offset:16
    v_mul_u32_u24 v48, 144, v5
    v_lshl_add_u32 v48, v6, 5, v48
    v_add_u32 v48, 131072, v48
    v_lshrrev_b32 v53, 2, v3
    v_lshrrev_b32 v54, 1, v53
    v_and_b32 v6, 1, v4
    v_lshl_add_u32 v54, v6, 1, v54
    v_lshl_add_u32 v5, v4, 3, v53
    v_lshlrev_b32 v5, 7, v5
    v_and_b32 v6, 3, v3
    v_lshl_add_u32 v5, v6, 3, v5
    v_add_u32 v5, s68, v5
    v_xor_b32 v6, 0, v54
    v_lshl_add_u32 v49, v6, 5, v5
    v_xor_b32 v6, 1, v54
    v_lshl_add_u32 v50, v6, 5, v5
    v_xor_b32 v6, 2, v54
    v_lshl_add_u32 v51, v6, 5, v5
    v_xor_b32 v6, 3, v54
    v_lshl_add_u32 v52, v6, 5, v5
    v_and_b32 v6, 7, v3
    v_xor_b32 v6, v6, v4
    v_lshlrev_b32 v5, 7, v3
    v_add_u32 v5, s68, v5
    v_lshl_add_u32 v55, v6, 4, v5
    v_xor_b32 v6, 4, v6
    v_lshl_add_u32 v56, v6, 4, v5
    s_add_u32 s69, s67, 65536
    s_add_u32 m0, s68, 16384
    s_nop 0
    buffer_load_dwordx4 v8, s[48:51], s69 offen lds
    s_add_u32 s69, s71, 128
    s_add_u32 m0, s68, 24576
    s_nop 0
    buffer_load_dwordx4 v10, s[36:39], s69 offen lds
    s_add_u32 s69, s67, 73728
    s_add_u32 m0, s68, 17408
    s_nop 0
    buffer_load_dwordx4 v9, s[48:51], s69 offen lds
    s_add_u32 s69, s71, 28800
    s_add_u32 m0, s68, 25600
    s_nop 0
    buffer_load_dwordx4 v10, s[36:39], s69 offen lds
    s_add_u32 s69, s67, 81920
    s_add_u32 m0, s68, 18432
    s_nop 0
    buffer_load_dwordx4 v8, s[48:51], s69 offen lds
    s_add_u32 s69, s71, 57472
    s_add_u32 m0, s68, 26624
    s_nop 0
    buffer_load_dwordx4 v10, s[36:39], s69 offen lds
    s_add_u32 s69, s67, 90112
    s_add_u32 m0, s68, 19456
    s_nop 0
    buffer_load_dwordx4 v9, s[48:51], s69 offen lds
    s_add_u32 s69, s71, 86144
    s_add_u32 m0, s68, 27648
    s_nop 0
    buffer_load_dwordx4 v10, s[36:39], s69 offen lds
    s_add_u32 s69, s67, 98304
    s_add_u32 m0, s68, 20480
    s_nop 0
    buffer_load_dwordx4 v8, s[48:51], s69 offen lds
    s_add_u32 s69, s71, 114816
    s_add_u32 m0, s68, 28672
    s_nop 0
    buffer_load_dwordx4 v10, s[36:39], s69 offen lds
    s_add_u32 s69, s67, 106496
    s_add_u32 m0, s68, 21504
    s_nop 0
    buffer_load_dwordx4 v9, s[48:51], s69 offen lds
    s_add_u32 s69, s71, 143488
    s_add_u32 m0, s68, 29696
    s_nop 0
    buffer_load_dwordx4 v10, s[36:39], s69 offen lds
    s_add_u32 s69, s67, 114688
    s_add_u32 m0, s68, 22528
    s_nop 0
    buffer_load_dwordx4 v8, s[48:51], s69 offen lds
    s_add_u32 s69, s71, 172160
    s_add_u32 m0, s68, 30720
    s_nop 0
    buffer_load_dwordx4 v10, s[36:39], s69 offen lds
    s_add_u32 s69, s67, 122880
    s_add_u32 m0, s68, 23552
    s_nop 0
    buffer_load_dwordx4 v9, s[48:51], s69 offen lds
    s_add_u32 s69, s71, 200832
    s_add_u32 m0, s68, 31744
    s_nop 0
    buffer_load_dwordx4 v10, s[36:39], s69 offen lds
    s_waitcnt vmcnt(16)
    ds_read_b64_tr_b16 v[124:125], v49 offset:0
    ds_read_b64_tr_b16 v[126:127], v49 offset:512
    ds_read_b64_tr_b16 v[128:129], v50 offset:0
    ds_read_b64_tr_b16 v[130:131], v50 offset:512
    ds_read_b64_tr_b16 v[132:133], v51 offset:0
    ds_read_b64_tr_b16 v[134:135], v51 offset:512
    ds_read_b64_tr_b16 v[136:137], v52 offset:0
    ds_read_b64_tr_b16 v[138:139], v52 offset:512
    ds_read_b128 v[156:159], v55 offset:8192
    ds_read_b128 v[160:163], v55 offset:10240
    ds_read_b128 v[164:167], v55 offset:12288
    ds_read_b128 v[168:171], v55 offset:14336
    ds_read_b64_tr_b16 v[140:141], v49 offset:4096
    ds_read_b64_tr_b16 v[142:143], v49 offset:4608
    ds_read_b64_tr_b16 v[144:145], v50 offset:4096
    ds_read_b64_tr_b16 v[146:147], v50 offset:4608
    ds_read_b64_tr_b16 v[148:149], v51 offset:4096
    ds_read_b64_tr_b16 v[150:151], v51 offset:4608
    ds_read_b64_tr_b16 v[152:153], v52 offset:4096
    ds_read_b64_tr_b16 v[154:155], v52 offset:4608
    ds_read_b128 v[172:175], v56 offset:8192
    ds_read_b128 v[176:179], v56 offset:10240
    ds_read_b128 v[180:183], v56 offset:12288
    ds_read_b128 v[184:187], v56 offset:14336
    s_waitcnt lgkmcnt(12)
    v_mfma_f32_16x16x32_bf16 v[60:63], v[124:127], v[156:159], 0
    v_mfma_f32_16x16x32_bf16 v[64:67], v[124:127], v[160:163], 0
    v_mfma_f32_16x16x32_bf16 v[68:71], v[124:127], v[164:167], 0
    v_mfma_f32_16x16x32_bf16 v[72:75], v[124:127], v[168:171], 0
    v_mfma_f32_16x16x32_bf16 v[76:79], v[128:131], v[156:159], 0
    v_mfma_f32_16x16x32_bf16 v[80:83], v[128:131], v[160:163], 0
    v_mfma_f32_16x16x32_bf16 v[84:87], v[128:131], v[164:167], 0
    v_mfma_f32_16x16x32_bf16 v[88:91], v[128:131], v[168:171], 0
    v_mfma_f32_16x16x32_bf16 v[92:95], v[132:135], v[156:159], 0
    v_mfma_f32_16x16x32_bf16 v[96:99], v[132:135], v[160:163], 0
    v_mfma_f32_16x16x32_bf16 v[100:103], v[132:135], v[164:167], 0
    v_mfma_f32_16x16x32_bf16 v[104:107], v[132:135], v[168:171], 0
    v_mfma_f32_16x16x32_bf16 v[108:111], v[136:139], v[156:159], 0
    v_mfma_f32_16x16x32_bf16 v[112:115], v[136:139], v[160:163], 0
    v_mfma_f32_16x16x32_bf16 v[116:119], v[136:139], v[164:167], 0
    v_mfma_f32_16x16x32_bf16 v[120:123], v[136:139], v[168:171], 0
    s_waitcnt lgkmcnt(0)
    v_mfma_f32_16x16x32_bf16 v[60:63], v[140:143], v[172:175], v[60:63]
    v_mfma_f32_16x16x32_bf16 v[64:67], v[140:143], v[176:179], v[64:67]
    v_mfma_f32_16x16x32_bf16 v[68:71], v[140:143], v[180:183], v[68:71]
    v_mfma_f32_16x16x32_bf16 v[72:75], v[140:143], v[184:187], v[72:75]
    v_mfma_f32_16x16x32_bf16 v[76:79], v[144:147], v[172:175], v[76:79]
    v_mfma_f32_16x16x32_bf16 v[80:83], v[144:147], v[176:179], v[80:83]
    v_mfma_f32_16x16x32_bf16 v[84:87], v[144:147], v[180:183], v[84:87]
    v_mfma_f32_16x16x32_bf16 v[88:91], v[144:147], v[184:187], v[88:91]
    v_mfma_f32_16x16x32_bf16 v[92:95], v[148:151], v[172:175], v[92:95]
    v_mfma_f32_16x16x32_bf16 v[96:99], v[148:151], v[176:179], v[96:99]
    v_mfma_f32_16x16x32_bf16 v[100:103], v[148:151], v[180:183], v[100:103]
    v_mfma_f32_16x16x32_bf16 v[104:107], v[148:151], v[184:187], v[104:107]
    v_mfma_f32_16x16x32_bf16 v[108:111], v[152:155], v[172:175], v[108:111]
    v_mfma_f32_16x16x32_bf16 v[112:115], v[152:155], v[176:179], v[112:115]
    v_mfma_f32_16x16x32_bf16 v[116:119], v[152:155], v[180:183], v[116:119]
    v_mfma_f32_16x16x32_bf16 v[120:123], v[152:155], v[184:187], v[120:123]
    s_add_u32 s69, s67, 131072
    s_add_u32 m0, s68, 0
    s_nop 0
    buffer_load_dwordx4 v8, s[48:51], s69 offen lds
    s_add_u32 s69, s71, 256
    s_add_u32 m0, s68, 8192
    s_nop 0
    buffer_load_dwordx4 v10, s[36:39], s69 offen lds
    s_add_u32 s69, s67, 139264
    s_add_u32 m0, s68, 1024
    s_nop 0
    buffer_load_dwordx4 v9, s[48:51], s69 offen lds
    s_add_u32 s69, s71, 28928
    s_add_u32 m0, s68, 9216
    s_nop 0
    buffer_load_dwordx4 v10, s[36:39], s69 offen lds
    s_add_u32 s69, s67, 147456
    s_add_u32 m0, s68, 2048
    s_nop 0
    buffer_load_dwordx4 v8, s[48:51], s69 offen lds
    s_add_u32 s69, s71, 57600
    s_add_u32 m0, s68, 10240
    s_nop 0
    buffer_load_dwordx4 v10, s[36:39], s69 offen lds
    s_add_u32 s69, s67, 155648
    s_add_u32 m0, s68, 3072
    s_nop 0
    buffer_load_dwordx4 v9, s[48:51], s69 offen lds
    s_add_u32 s69, s71, 86272
    s_add_u32 m0, s68, 11264
    s_nop 0
    buffer_load_dwordx4 v10, s[36:39], s69 offen lds
    s_add_u32 s69, s67, 163840
    s_add_u32 m0, s68, 4096
    s_nop 0
    buffer_load_dwordx4 v8, s[48:51], s69 offen lds
    s_add_u32 s69, s71, 114944
    s_add_u32 m0, s68, 12288
    s_nop 0
    buffer_load_dwordx4 v10, s[36:39], s69 offen lds
    s_add_u32 s69, s67, 172032
    s_add_u32 m0, s68, 5120
    s_nop 0
    buffer_load_dwordx4 v9, s[48:51], s69 offen lds
    s_add_u32 s69, s71, 143616
    s_add_u32 m0, s68, 13312
    s_nop 0
    buffer_load_dwordx4 v10, s[36:39], s69 offen lds
    s_add_u32 s69, s67, 180224
    s_add_u32 m0, s68, 6144
    s_nop 0
    buffer_load_dwordx4 v8, s[48:51], s69 offen lds
    s_add_u32 s69, s71, 172288
    s_add_u32 m0, s68, 14336
    s_nop 0
    buffer_load_dwordx4 v10, s[36:39], s69 offen lds
    s_add_u32 s69, s67, 188416
    s_add_u32 m0, s68, 7168
    s_nop 0
    buffer_load_dwordx4 v9, s[48:51], s69 offen lds
    s_add_u32 s69, s71, 200960
    s_add_u32 m0, s68, 15360
    s_nop 0
    buffer_load_dwordx4 v10, s[36:39], s69 offen lds
    s_waitcnt vmcnt(16)
    ds_read_b64_tr_b16 v[124:125], v49 offset:16384
    ds_read_b64_tr_b16 v[126:127], v49 offset:16896
    ds_read_b64_tr_b16 v[128:129], v50 offset:16384
    ds_read_b64_tr_b16 v[130:131], v50 offset:16896
    ds_read_b64_tr_b16 v[132:133], v51 offset:16384
    ds_read_b64_tr_b16 v[134:135], v51 offset:16896
    ds_read_b64_tr_b16 v[136:137], v52 offset:16384
    ds_read_b64_tr_b16 v[138:139], v52 offset:16896
    ds_read_b128 v[156:159], v55 offset:24576
    ds_read_b128 v[160:163], v55 offset:26624
    ds_read_b128 v[164:167], v55 offset:28672
    ds_read_b128 v[168:171], v55 offset:30720
    ds_read_b64_tr_b16 v[140:141], v49 offset:20480
    ds_read_b64_tr_b16 v[142:143], v49 offset:20992
    ds_read_b64_tr_b16 v[144:145], v50 offset:20480
    ds_read_b64_tr_b16 v[146:147], v50 offset:20992
    ds_read_b64_tr_b16 v[148:149], v51 offset:20480
    ds_read_b64_tr_b16 v[150:151], v51 offset:20992
    ds_read_b64_tr_b16 v[152:153], v52 offset:20480
    ds_read_b64_tr_b16 v[154:155], v52 offset:20992
    ds_read_b128 v[172:175], v56 offset:24576
    ds_read_b128 v[176:179], v56 offset:26624
    ds_read_b128 v[180:183], v56 offset:28672
    ds_read_b128 v[184:187], v56 offset:30720
    s_waitcnt lgkmcnt(12)
    v_mfma_f32_16x16x32_bf16 v[60:63], v[124:127], v[156:159], v[60:63]
    v_mfma_f32_16x16x32_bf16 v[64:67], v[124:127], v[160:163], v[64:67]
    v_mfma_f32_16x16x32_bf16 v[68:71], v[124:127], v[164:167], v[68:71]
    v_mfma_f32_16x16x32_bf16 v[72:75], v[124:127], v[168:171], v[72:75]
    v_mfma_f32_16x16x32_bf16 v[76:79], v[128:131], v[156:159], v[76:79]
    v_mfma_f32_16x16x32_bf16 v[80:83], v[128:131], v[160:163], v[80:83]
    v_mfma_f32_16x16x32_bf16 v[84:87], v[128:131], v[164:167], v[84:87]
    v_mfma_f32_16x16x32_bf16 v[88:91], v[128:131], v[168:171], v[88:91]
    v_mfma_f32_16x16x32_bf16 v[92:95], v[132:135], v[156:159], v[92:95]
    v_mfma_f32_16x16x32_bf16 v[96:99], v[132:135], v[160:163], v[96:99]
    v_mfma_f32_16x16x32_bf16 v[100:103], v[132:135], v[164:167], v[100:103]
    v_mfma_f32_16x16x32_bf16 v[104:107], v[132:135], v[168:171], v[104:107]
    v_mfma_f32_16x16x32_bf16 v[108:111], v[136:139], v[156:159], v[108:111]
    v_mfma_f32_16x16x32_bf16 v[112:115], v[136:139], v[160:163], v[112:115]
    v_mfma_f32_16x16x32_bf16 v[116:119], v[136:139], v[164:167], v[116:119]
    v_mfma_f32_16x16x32_bf16 v[120:123], v[136:139], v[168:171], v[120:123]
    s_waitcnt lgkmcnt(0)
    v_mfma_f32_16x16x32_bf16 v[60:63], v[140:143], v[172:175], v[60:63]
    v_mfma_f32_16x16x32_bf16 v[64:67], v[140:143], v[176:179], v[64:67]
    v_mfma_f32_16x16x32_bf16 v[68:71], v[140:143], v[180:183], v[68:71]
    v_mfma_f32_16x16x32_bf16 v[72:75], v[140:143], v[184:187], v[72:75]
    v_mfma_f32_16x16x32_bf16 v[76:79], v[144:147], v[172:175], v[76:79]
    v_mfma_f32_16x16x32_bf16 v[80:83], v[144:147], v[176:179], v[80:83]
    v_mfma_f32_16x16x32_bf16 v[84:87], v[144:147], v[180:183], v[84:87]
    v_mfma_f32_16x16x32_bf16 v[88:91], v[144:147], v[184:187], v[88:91]
    v_mfma_f32_16x16x32_bf16 v[92:95], v[148:151], v[172:175], v[92:95]
    v_mfma_f32_16x16x32_bf16 v[96:99], v[148:151], v[176:179], v[96:99]
    v_mfma_f32_16x16x32_bf16 v[100:103], v[148:151], v[180:183], v[100:103]
    v_mfma_f32_16x16x32_bf16 v[104:107], v[148:151], v[184:187], v[104:107]
    v_mfma_f32_16x16x32_bf16 v[108:111], v[152:155], v[172:175], v[108:111]
    v_mfma_f32_16x16x32_bf16 v[112:115], v[152:155], v[176:179], v[112:115]
    v_mfma_f32_16x16x32_bf16 v[116:119], v[152:155], v[180:183], v[116:119]
    v_mfma_f32_16x16x32_bf16 v[120:123], v[152:155], v[184:187], v[120:123]
    s_add_u32 s69, s67, 196608
    s_add_u32 m0, s68, 16384
    s_nop 0
    buffer_load_dwordx4 v8, s[48:51], s69 offen lds
    s_add_u32 s69, s71, 384
    s_add_u32 m0, s68, 24576
    s_nop 0
    buffer_load_dwordx4 v10, s[36:39], s69 offen lds
    s_add_u32 s69, s67, 204800
    s_add_u32 m0, s68, 17408
    s_nop 0
    buffer_load_dwordx4 v9, s[48:51], s69 offen lds
    s_add_u32 s69, s71, 29056
    s_add_u32 m0, s68, 25600
    s_nop 0
    buffer_load_dwordx4 v10, s[36:39], s69 offen lds
    s_add_u32 s69, s67, 212992
    s_add_u32 m0, s68, 18432
    s_nop 0
    buffer_load_dwordx4 v8, s[48:51], s69 offen lds
    s_add_u32 s69, s71, 57728
    s_add_u32 m0, s68, 26624
    s_nop 0
    buffer_load_dwordx4 v10, s[36:39], s69 offen lds
    s_add_u32 s69, s67, 221184
    s_add_u32 m0, s68, 19456
    s_nop 0
    buffer_load_dwordx4 v9, s[48:51], s69 offen lds
    s_add_u32 s69, s71, 86400
    s_add_u32 m0, s68, 27648
    s_nop 0
    buffer_load_dwordx4 v10, s[36:39], s69 offen lds
    s_add_u32 s69, s67, 229376
    s_add_u32 m0, s68, 20480
    s_nop 0
    buffer_load_dwordx4 v8, s[48:51], s69 offen lds
    s_add_u32 s69, s71, 115072
    s_add_u32 m0, s68, 28672
    s_nop 0
    buffer_load_dwordx4 v10, s[36:39], s69 offen lds
    s_add_u32 s69, s67, 237568
    s_add_u32 m0, s68, 21504
    s_nop 0
    buffer_load_dwordx4 v9, s[48:51], s69 offen lds
    s_add_u32 s69, s71, 143744
    s_add_u32 m0, s68, 29696
    s_nop 0
    buffer_load_dwordx4 v10, s[36:39], s69 offen lds
    s_add_u32 s69, s67, 245760
    s_add_u32 m0, s68, 22528
    s_nop 0
    buffer_load_dwordx4 v8, s[48:51], s69 offen lds
    s_add_u32 s69, s71, 172416
    s_add_u32 m0, s68, 30720
    s_nop 0
    buffer_load_dwordx4 v10, s[36:39], s69 offen lds
    s_add_u32 s69, s67, 253952
    s_add_u32 m0, s68, 23552
    s_nop 0
    buffer_load_dwordx4 v9, s[48:51], s69 offen lds
    s_add_u32 s69, s71, 201088
    s_add_u32 m0, s68, 31744
    s_nop 0
    buffer_load_dwordx4 v10, s[36:39], s69 offen lds
    s_waitcnt vmcnt(16)
    ds_read_b64_tr_b16 v[124:125], v49 offset:0
    ds_read_b64_tr_b16 v[126:127], v49 offset:512
    ds_read_b64_tr_b16 v[128:129], v50 offset:0
    ds_read_b64_tr_b16 v[130:131], v50 offset:512
    ds_read_b64_tr_b16 v[132:133], v51 offset:0
    ds_read_b64_tr_b16 v[134:135], v51 offset:512
    ds_read_b64_tr_b16 v[136:137], v52 offset:0
    ds_read_b64_tr_b16 v[138:139], v52 offset:512
    ds_read_b128 v[156:159], v55 offset:8192
    ds_read_b128 v[160:163], v55 offset:10240
    ds_read_b128 v[164:167], v55 offset:12288
    ds_read_b128 v[168:171], v55 offset:14336
    ds_read_b64_tr_b16 v[140:141], v49 offset:4096
    ds_read_b64_tr_b16 v[142:143], v49 offset:4608
    ds_read_b64_tr_b16 v[144:145], v50 offset:4096
    ds_read_b64_tr_b16 v[146:147], v50 offset:4608
    ds_read_b64_tr_b16 v[148:149], v51 offset:4096
    ds_read_b64_tr_b16 v[150:151], v51 offset:4608
    ds_read_b64_tr_b16 v[152:153], v52 offset:4096
    ds_read_b64_tr_b16 v[154:155], v52 offset:4608
    ds_read_b128 v[172:175], v56 offset:8192
    ds_read_b128 v[176:179], v56 offset:10240
    ds_read_b128 v[180:183], v56 offset:12288
    ds_read_b128 v[184:187], v56 offset:14336
    s_waitcnt lgkmcnt(12)
    v_mfma_f32_16x16x32_bf16 v[60:63], v[124:127], v[156:159], v[60:63]
    v_mfma_f32_16x16x32_bf16 v[64:67], v[124:127], v[160:163], v[64:67]
    v_mfma_f32_16x16x32_bf16 v[68:71], v[124:127], v[164:167], v[68:71]
    v_mfma_f32_16x16x32_bf16 v[72:75], v[124:127], v[168:171], v[72:75]
    v_mfma_f32_16x16x32_bf16 v[76:79], v[128:131], v[156:159], v[76:79]
    v_mfma_f32_16x16x32_bf16 v[80:83], v[128:131], v[160:163], v[80:83]
    v_mfma_f32_16x16x32_bf16 v[84:87], v[128:131], v[164:167], v[84:87]
    v_mfma_f32_16x16x32_bf16 v[88:91], v[128:131], v[168:171], v[88:91]
    v_mfma_f32_16x16x32_bf16 v[92:95], v[132:135], v[156:159], v[92:95]
    v_mfma_f32_16x16x32_bf16 v[96:99], v[132:135], v[160:163], v[96:99]
    v_mfma_f32_16x16x32_bf16 v[100:103], v[132:135], v[164:167], v[100:103]
    v_mfma_f32_16x16x32_bf16 v[104:107], v[132:135], v[168:171], v[104:107]
    v_mfma_f32_16x16x32_bf16 v[108:111], v[136:139], v[156:159], v[108:111]
    v_mfma_f32_16x16x32_bf16 v[112:115], v[136:139], v[160:163], v[112:115]
    v_mfma_f32_16x16x32_bf16 v[116:119], v[136:139], v[164:167], v[116:119]
    v_mfma_f32_16x16x32_bf16 v[120:123], v[136:139], v[168:171], v[120:123]
    s_waitcnt lgkmcnt(0)
    v_mfma_f32_16x16x32_bf16 v[60:63], v[140:143], v[172:175], v[60:63]
    v_mfma_f32_16x16x32_bf16 v[64:67], v[140:143], v[176:179], v[64:67]
    v_mfma_f32_16x16x32_bf16 v[68:71], v[140:143], v[180:183], v[68:71]
    v_mfma_f32_16x16x32_bf16 v[72:75], v[140:143], v[184:187], v[72:75]
    v_mfma_f32_16x16x32_bf16 v[76:79], v[144:147], v[172:175], v[76:79]
    v_mfma_f32_16x16x32_bf16 v[80:83], v[144:147], v[176:179], v[80:83]
    v_mfma_f32_16x16x32_bf16 v[84:87], v[144:147], v[180:183], v[84:87]
    v_mfma_f32_16x16x32_bf16 v[88:91], v[144:147], v[184:187], v[88:91]
    v_mfma_f32_16x16x32_bf16 v[92:95], v[148:151], v[172:175], v[92:95]
    v_mfma_f32_16x16x32_bf16 v[96:99], v[148:151], v[176:179], v[96:99]
    v_mfma_f32_16x16x32_bf16 v[100:103], v[148:151], v[180:183], v[100:103]
    v_mfma_f32_16x16x32_bf16 v[104:107], v[148:151], v[184:187], v[104:107]
    v_mfma_f32_16x16x32_bf16 v[108:111], v[152:155], v[172:175], v[108:111]
    v_mfma_f32_16x16x32_bf16 v[112:115], v[152:155], v[176:179], v[112:115]
    v_mfma_f32_16x16x32_bf16 v[116:119], v[152:155], v[180:183], v[116:119]
    v_mfma_f32_16x16x32_bf16 v[120:123], v[152:155], v[184:187], v[120:123]
    s_add_u32 s69, s67, 262144
    s_add_u32 m0, s68, 0
    s_nop 0
    buffer_load_dwordx4 v8, s[48:51], s69 offen lds
    s_add_u32 s69, s71, 512
    s_add_u32 m0, s68, 8192
    s_nop 0
    buffer_load_dwordx4 v10, s[36:39], s69 offen lds
    s_add_u32 s69, s67, 270336
    s_add_u32 m0, s68, 1024
    s_nop 0
    buffer_load_dwordx4 v9, s[48:51], s69 offen lds
    s_add_u32 s69, s71, 29184
    s_add_u32 m0, s68, 9216
    s_nop 0
    buffer_load_dwordx4 v10, s[36:39], s69 offen lds
    s_add_u32 s69, s67, 278528
    s_add_u32 m0, s68, 2048
    s_nop 0
    buffer_load_dwordx4 v8, s[48:51], s69 offen lds
    s_add_u32 s69, s71, 57856
    s_add_u32 m0, s68, 10240
    s_nop 0
    buffer_load_dwordx4 v10, s[36:39], s69 offen lds
    s_add_u32 s69, s67, 286720
    s_add_u32 m0, s68, 3072
    s_nop 0
    buffer_load_dwordx4 v9, s[48:51], s69 offen lds
    s_add_u32 s69, s71, 86528
    s_add_u32 m0, s68, 11264
    s_nop 0
    buffer_load_dwordx4 v10, s[36:39], s69 offen lds
    s_add_u32 s69, s67, 294912
    s_add_u32 m0, s68, 4096
    s_nop 0
    buffer_load_dwordx4 v8, s[48:51], s69 offen lds
    s_add_u32 s69, s71, 115200
    s_add_u32 m0, s68, 12288
    s_nop 0
    buffer_load_dwordx4 v10, s[36:39], s69 offen lds
    s_add_u32 s69, s67, 303104
    s_add_u32 m0, s68, 5120
    s_nop 0
    buffer_load_dwordx4 v9, s[48:51], s69 offen lds
    s_add_u32 s69, s71, 143872
    s_add_u32 m0, s68, 13312
    s_nop 0
    buffer_load_dwordx4 v10, s[36:39], s69 offen lds
    s_add_u32 s69, s67, 311296
    s_add_u32 m0, s68, 6144
    s_nop 0
    buffer_load_dwordx4 v8, s[48:51], s69 offen lds
    s_add_u32 s69, s71, 172544
    s_add_u32 m0, s68, 14336
    s_nop 0
    buffer_load_dwordx4 v10, s[36:39], s69 offen lds
    s_add_u32 s69, s67, 319488
    s_add_u32 m0, s68, 7168
    s_nop 0
    buffer_load_dwordx4 v9, s[48:51], s69 offen lds
    s_add_u32 s69, s71, 201216
    s_add_u32 m0, s68, 15360
    s_nop 0
    buffer_load_dwordx4 v10, s[36:39], s69 offen lds
    s_waitcnt vmcnt(16)
    ds_read_b64_tr_b16 v[124:125], v49 offset:16384
    ds_read_b64_tr_b16 v[126:127], v49 offset:16896
    ds_read_b64_tr_b16 v[128:129], v50 offset:16384
    ds_read_b64_tr_b16 v[130:131], v50 offset:16896
    ds_read_b64_tr_b16 v[132:133], v51 offset:16384
    ds_read_b64_tr_b16 v[134:135], v51 offset:16896
    ds_read_b64_tr_b16 v[136:137], v52 offset:16384
    ds_read_b64_tr_b16 v[138:139], v52 offset:16896
    ds_read_b128 v[156:159], v55 offset:24576
    ds_read_b128 v[160:163], v55 offset:26624
    ds_read_b128 v[164:167], v55 offset:28672
    ds_read_b128 v[168:171], v55 offset:30720
    ds_read_b64_tr_b16 v[140:141], v49 offset:20480
    ds_read_b64_tr_b16 v[142:143], v49 offset:20992
    ds_read_b64_tr_b16 v[144:145], v50 offset:20480
    ds_read_b64_tr_b16 v[146:147], v50 offset:20992
    ds_read_b64_tr_b16 v[148:149], v51 offset:20480
    ds_read_b64_tr_b16 v[150:151], v51 offset:20992
    ds_read_b64_tr_b16 v[152:153], v52 offset:20480
    ds_read_b64_tr_b16 v[154:155], v52 offset:20992
    ds_read_b128 v[172:175], v56 offset:24576
    ds_read_b128 v[176:179], v56 offset:26624
    ds_read_b128 v[180:183], v56 offset:28672
    ds_read_b128 v[184:187], v56 offset:30720
    s_waitcnt lgkmcnt(12)
    v_mfma_f32_16x16x32_bf16 v[60:63], v[124:127], v[156:159], v[60:63]
    v_mfma_f32_16x16x32_bf16 v[64:67], v[124:127], v[160:163], v[64:67]
    v_mfma_f32_16x16x32_bf16 v[68:71], v[124:127], v[164:167], v[68:71]
    v_mfma_f32_16x16x32_bf16 v[72:75], v[124:127], v[168:171], v[72:75]
    v_mfma_f32_16x16x32_bf16 v[76:79], v[128:131], v[156:159], v[76:79]
    v_mfma_f32_16x16x32_bf16 v[80:83], v[128:131], v[160:163], v[80:83]
    v_mfma_f32_16x16x32_bf16 v[84:87], v[128:131], v[164:167], v[84:87]
    v_mfma_f32_16x16x32_bf16 v[88:91], v[128:131], v[168:171], v[88:91]
    v_mfma_f32_16x16x32_bf16 v[92:95], v[132:135], v[156:159], v[92:95]
    v_mfma_f32_16x16x32_bf16 v[96:99], v[132:135], v[160:163], v[96:99]
    v_mfma_f32_16x16x32_bf16 v[100:103], v[132:135], v[164:167], v[100:103]
    v_mfma_f32_16x16x32_bf16 v[104:107], v[132:135], v[168:171], v[104:107]
    v_mfma_f32_16x16x32_bf16 v[108:111], v[136:139], v[156:159], v[108:111]
    v_mfma_f32_16x16x32_bf16 v[112:115], v[136:139], v[160:163], v[112:115]
    v_mfma_f32_16x16x32_bf16 v[116:119], v[136:139], v[164:167], v[116:119]
    v_mfma_f32_16x16x32_bf16 v[120:123], v[136:139], v[168:171], v[120:123]
    s_waitcnt lgkmcnt(0)
    v_mfma_f32_16x16x32_bf16 v[60:63], v[140:143], v[172:175], v[60:63]
    v_mfma_f32_16x16x32_bf16 v[64:67], v[140:143], v[176:179], v[64:67]
    v_mfma_f32_16x16x32_bf16 v[68:71], v[140:143], v[180:183], v[68:71]
    v_mfma_f32_16x16x32_bf16 v[72:75], v[140:143], v[184:187], v[72:75]
    v_mfma_f32_16x16x32_bf16 v[76:79], v[144:147], v[172:175], v[76:79]
    v_mfma_f32_16x16x32_bf16 v[80:83], v[144:147], v[176:179], v[80:83]
    v_mfma_f32_16x16x32_bf16 v[84:87], v[144:147], v[180:183], v[84:87]
    v_mfma_f32_16x16x32_bf16 v[88:91], v[144:147], v[184:187], v[88:91]
    v_mfma_f32_16x16x32_bf16 v[92:95], v[148:151], v[172:175], v[92:95]
    v_mfma_f32_16x16x32_bf16 v[96:99], v[148:151], v[176:179], v[96:99]
    v_mfma_f32_16x16x32_bf16 v[100:103], v[148:151], v[180:183], v[100:103]
    v_mfma_f32_16x16x32_bf16 v[104:107], v[148:151], v[184:187], v[104:107]
    v_mfma_f32_16x16x32_bf16 v[108:111], v[152:155], v[172:175], v[108:111]
    v_mfma_f32_16x16x32_bf16 v[112:115], v[152:155], v[176:179], v[112:115]
    v_mfma_f32_16x16x32_bf16 v[116:119], v[152:155], v[180:183], v[116:119]
    v_mfma_f32_16x16x32_bf16 v[120:123], v[152:155], v[184:187], v[120:123]
    s_add_u32 s69, s67, 327680
    s_add_u32 m0, s68, 16384
    s_nop 0
    buffer_load_dwordx4 v8, s[48:51], s69 offen lds
    s_add_u32 s69, s71, 640
    s_add_u32 m0, s68, 24576
    s_nop 0
    buffer_load_dwordx4 v10, s[36:39], s69 offen lds
    s_add_u32 s69, s67, 335872
    s_add_u32 m0, s68, 17408
    s_nop 0
    buffer_load_dwordx4 v9, s[48:51], s69 offen lds
    s_add_u32 s69, s71, 29312
    s_add_u32 m0, s68, 25600
    s_nop 0
    buffer_load_dwordx4 v10, s[36:39], s69 offen lds
    s_add_u32 s69, s67, 344064
    s_add_u32 m0, s68, 18432
    s_nop 0
    buffer_load_dwordx4 v8, s[48:51], s69 offen lds
    s_add_u32 s69, s71, 57984
    s_add_u32 m0, s68, 26624
    s_nop 0
    buffer_load_dwordx4 v10, s[36:39], s69 offen lds
    s_add_u32 s69, s67, 352256
    s_add_u32 m0, s68, 19456
    s_nop 0
    buffer_load_dwordx4 v9, s[48:51], s69 offen lds
    s_add_u32 s69, s71, 86656
    s_add_u32 m0, s68, 27648
    s_nop 0
    buffer_load_dwordx4 v10, s[36:39], s69 offen lds
    s_add_u32 s69, s67, 360448
    s_add_u32 m0, s68, 20480
    s_nop 0
    buffer_load_dwordx4 v8, s[48:51], s69 offen lds
    s_add_u32 s69, s71, 115328
    s_add_u32 m0, s68, 28672
    s_nop 0
    buffer_load_dwordx4 v10, s[36:39], s69 offen lds
    s_add_u32 s69, s67, 368640
    s_add_u32 m0, s68, 21504
    s_nop 0
    buffer_load_dwordx4 v9, s[48:51], s69 offen lds
    s_add_u32 s69, s71, 144000
    s_add_u32 m0, s68, 29696
    s_nop 0
    buffer_load_dwordx4 v10, s[36:39], s69 offen lds
    s_add_u32 s69, s67, 376832
    s_add_u32 m0, s68, 22528
    s_nop 0
    buffer_load_dwordx4 v8, s[48:51], s69 offen lds
    s_add_u32 s69, s71, 172672
    s_add_u32 m0, s68, 30720
    s_nop 0
    buffer_load_dwordx4 v10, s[36:39], s69 offen lds
    s_add_u32 s69, s67, 385024
    s_add_u32 m0, s68, 23552
    s_nop 0
    buffer_load_dwordx4 v9, s[48:51], s69 offen lds
    s_add_u32 s69, s71, 201344
    s_add_u32 m0, s68, 31744
    s_nop 0
    buffer_load_dwordx4 v10, s[36:39], s69 offen lds
    s_waitcnt vmcnt(16)
    ds_read_b64_tr_b16 v[124:125], v49 offset:0
    ds_read_b64_tr_b16 v[126:127], v49 offset:512
    ds_read_b64_tr_b16 v[128:129], v50 offset:0
    ds_read_b64_tr_b16 v[130:131], v50 offset:512
    ds_read_b64_tr_b16 v[132:133], v51 offset:0
    ds_read_b64_tr_b16 v[134:135], v51 offset:512
    ds_read_b64_tr_b16 v[136:137], v52 offset:0
    ds_read_b64_tr_b16 v[138:139], v52 offset:512
    ds_read_b128 v[156:159], v55 offset:8192
    ds_read_b128 v[160:163], v55 offset:10240
    ds_read_b128 v[164:167], v55 offset:12288
    ds_read_b128 v[168:171], v55 offset:14336
    ds_read_b64_tr_b16 v[140:141], v49 offset:4096
    ds_read_b64_tr_b16 v[142:143], v49 offset:4608
    ds_read_b64_tr_b16 v[144:145], v50 offset:4096
    ds_read_b64_tr_b16 v[146:147], v50 offset:4608
    ds_read_b64_tr_b16 v[148:149], v51 offset:4096
    ds_read_b64_tr_b16 v[150:151], v51 offset:4608
    ds_read_b64_tr_b16 v[152:153], v52 offset:4096
    ds_read_b64_tr_b16 v[154:155], v52 offset:4608
    ds_read_b128 v[172:175], v56 offset:8192
    ds_read_b128 v[176:179], v56 offset:10240
    ds_read_b128 v[180:183], v56 offset:12288
    ds_read_b128 v[184:187], v56 offset:14336
    s_waitcnt lgkmcnt(12)
    v_mfma_f32_16x16x32_bf16 v[60:63], v[124:127], v[156:159], v[60:63]
    v_mfma_f32_16x16x32_bf16 v[64:67], v[124:127], v[160:163], v[64:67]
    v_mfma_f32_16x16x32_bf16 v[68:71], v[124:127], v[164:167], v[68:71]
    v_mfma_f32_16x16x32_bf16 v[72:75], v[124:127], v[168:171], v[72:75]
    v_mfma_f32_16x16x32_bf16 v[76:79], v[128:131], v[156:159], v[76:79]
    v_mfma_f32_16x16x32_bf16 v[80:83], v[128:131], v[160:163], v[80:83]
    v_mfma_f32_16x16x32_bf16 v[84:87], v[128:131], v[164:167], v[84:87]
    v_mfma_f32_16x16x32_bf16 v[88:91], v[128:131], v[168:171], v[88:91]
    v_mfma_f32_16x16x32_bf16 v[92:95], v[132:135], v[156:159], v[92:95]
    v_mfma_f32_16x16x32_bf16 v[96:99], v[132:135], v[160:163], v[96:99]
    v_mfma_f32_16x16x32_bf16 v[100:103], v[132:135], v[164:167], v[100:103]
    v_mfma_f32_16x16x32_bf16 v[104:107], v[132:135], v[168:171], v[104:107]
    v_mfma_f32_16x16x32_bf16 v[108:111], v[136:139], v[156:159], v[108:111]
    v_mfma_f32_16x16x32_bf16 v[112:115], v[136:139], v[160:163], v[112:115]
    v_mfma_f32_16x16x32_bf16 v[116:119], v[136:139], v[164:167], v[116:119]
    v_mfma_f32_16x16x32_bf16 v[120:123], v[136:139], v[168:171], v[120:123]
    s_waitcnt lgkmcnt(0)
    v_mfma_f32_16x16x32_bf16 v[60:63], v[140:143], v[172:175], v[60:63]
    v_mfma_f32_16x16x32_bf16 v[64:67], v[140:143], v[176:179], v[64:67]
    v_mfma_f32_16x16x32_bf16 v[68:71], v[140:143], v[180:183], v[68:71]
    v_mfma_f32_16x16x32_bf16 v[72:75], v[140:143], v[184:187], v[72:75]
    v_mfma_f32_16x16x32_bf16 v[76:79], v[144:147], v[172:175], v[76:79]
    v_mfma_f32_16x16x32_bf16 v[80:83], v[144:147], v[176:179], v[80:83]
    v_mfma_f32_16x16x32_bf16 v[84:87], v[144:147], v[180:183], v[84:87]
    v_mfma_f32_16x16x32_bf16 v[88:91], v[144:147], v[184:187], v[88:91]
    v_mfma_f32_16x16x32_bf16 v[92:95], v[148:151], v[172:175], v[92:95]
    v_mfma_f32_16x16x32_bf16 v[96:99], v[148:151], v[176:179], v[96:99]
    v_mfma_f32_16x16x32_bf16 v[100:103], v[148:151], v[180:183], v[100:103]
    v_mfma_f32_16x16x32_bf16 v[104:107], v[148:151], v[184:187], v[104:107]
    v_mfma_f32_16x16x32_bf16 v[108:111], v[152:155], v[172:175], v[108:111]
    v_mfma_f32_16x16x32_bf16 v[112:115], v[152:155], v[176:179], v[112:115]
    v_mfma_f32_16x16x32_bf16 v[116:119], v[152:155], v[180:183], v[116:119]
    v_mfma_f32_16x16x32_bf16 v[120:123], v[152:155], v[184:187], v[120:123]
    s_add_u32 s69, s67, 393216
    s_add_u32 m0, s68, 0
    s_nop 0
    buffer_load_dwordx4 v8, s[48:51], s69 offen lds
    s_add_u32 s69, s71, 768
    s_add_u32 m0, s68, 8192
    s_nop 0
    buffer_load_dwordx4 v10, s[36:39], s69 offen lds
    s_add_u32 s69, s67, 401408
    s_add_u32 m0, s68, 1024
    s_nop 0
    buffer_load_dwordx4 v9, s[48:51], s69 offen lds
    s_add_u32 s69, s71, 29440
    s_add_u32 m0, s68, 9216
    s_nop 0
    buffer_load_dwordx4 v10, s[36:39], s69 offen lds
    s_add_u32 s69, s67, 409600
    s_add_u32 m0, s68, 2048
    s_nop 0
    buffer_load_dwordx4 v8, s[48:51], s69 offen lds
    s_add_u32 s69, s71, 58112
    s_add_u32 m0, s68, 10240
    s_nop 0
    buffer_load_dwordx4 v10, s[36:39], s69 offen lds
    s_add_u32 s69, s67, 417792
    s_add_u32 m0, s68, 3072
    s_nop 0
    buffer_load_dwordx4 v9, s[48:51], s69 offen lds
    s_add_u32 s69, s71, 86784
    s_add_u32 m0, s68, 11264
    s_nop 0
    buffer_load_dwordx4 v10, s[36:39], s69 offen lds
    s_add_u32 s69, s67, 425984
    s_add_u32 m0, s68, 4096
    s_nop 0
    buffer_load_dwordx4 v8, s[48:51], s69 offen lds
    s_add_u32 s69, s71, 115456
    s_add_u32 m0, s68, 12288
    s_nop 0
    buffer_load_dwordx4 v10, s[36:39], s69 offen lds
    s_add_u32 s69, s67, 434176
    s_add_u32 m0, s68, 5120
    s_nop 0
    buffer_load_dwordx4 v9, s[48:51], s69 offen lds
    s_add_u32 s69, s71, 144128
    s_add_u32 m0, s68, 13312
    s_nop 0
    buffer_load_dwordx4 v10, s[36:39], s69 offen lds
    s_add_u32 s69, s67, 442368
    s_add_u32 m0, s68, 6144
    s_nop 0
    buffer_load_dwordx4 v8, s[48:51], s69 offen lds
    s_add_u32 s69, s71, 172800
    s_add_u32 m0, s68, 14336
    s_nop 0
    buffer_load_dwordx4 v10, s[36:39], s69 offen lds
    s_add_u32 s69, s67, 450560
    s_add_u32 m0, s68, 7168
    s_nop 0
    buffer_load_dwordx4 v9, s[48:51], s69 offen lds
    s_add_u32 s69, s71, 201472
    s_add_u32 m0, s68, 15360
    s_nop 0
    buffer_load_dwordx4 v10, s[36:39], s69 offen lds
    s_waitcnt vmcnt(16)
    ds_read_b64_tr_b16 v[124:125], v49 offset:16384
    ds_read_b64_tr_b16 v[126:127], v49 offset:16896
    ds_read_b64_tr_b16 v[128:129], v50 offset:16384
    ds_read_b64_tr_b16 v[130:131], v50 offset:16896
    ds_read_b64_tr_b16 v[132:133], v51 offset:16384
    ds_read_b64_tr_b16 v[134:135], v51 offset:16896
    ds_read_b64_tr_b16 v[136:137], v52 offset:16384
    ds_read_b64_tr_b16 v[138:139], v52 offset:16896
    ds_read_b128 v[156:159], v55 offset:24576
    ds_read_b128 v[160:163], v55 offset:26624
    ds_read_b128 v[164:167], v55 offset:28672
    ds_read_b128 v[168:171], v55 offset:30720
    ds_read_b64_tr_b16 v[140:141], v49 offset:20480
    ds_read_b64_tr_b16 v[142:143], v49 offset:20992
    ds_read_b64_tr_b16 v[144:145], v50 offset:20480
    ds_read_b64_tr_b16 v[146:147], v50 offset:20992
    ds_read_b64_tr_b16 v[148:149], v51 offset:20480
    ds_read_b64_tr_b16 v[150:151], v51 offset:20992
    ds_read_b64_tr_b16 v[152:153], v52 offset:20480
    ds_read_b64_tr_b16 v[154:155], v52 offset:20992
    ds_read_b128 v[172:175], v56 offset:24576
    ds_read_b128 v[176:179], v56 offset:26624
    ds_read_b128 v[180:183], v56 offset:28672
    ds_read_b128 v[184:187], v56 offset:30720
    s_waitcnt lgkmcnt(12)
    v_mfma_f32_16x16x32_bf16 v[60:63], v[124:127], v[156:159], v[60:63]
    v_mfma_f32_16x16x32_bf16 v[64:67], v[124:127], v[160:163], v[64:67]
    v_mfma_f32_16x16x32_bf16 v[68:71], v[124:127], v[164:167], v[68:71]
    v_mfma_f32_16x16x32_bf16 v[72:75], v[124:127], v[168:171], v[72:75]
    v_mfma_f32_16x16x32_bf16 v[76:79], v[128:131], v[156:159], v[76:79]
    v_mfma_f32_16x16x32_bf16 v[80:83], v[128:131], v[160:163], v[80:83]
    v_mfma_f32_16x16x32_bf16 v[84:87], v[128:131], v[164:167], v[84:87]
    v_mfma_f32_16x16x32_bf16 v[88:91], v[128:131], v[168:171], v[88:91]
    v_mfma_f32_16x16x32_bf16 v[92:95], v[132:135], v[156:159], v[92:95]
    v_mfma_f32_16x16x32_bf16 v[96:99], v[132:135], v[160:163], v[96:99]
    v_mfma_f32_16x16x32_bf16 v[100:103], v[132:135], v[164:167], v[100:103]
    v_mfma_f32_16x16x32_bf16 v[104:107], v[132:135], v[168:171], v[104:107]
    v_mfma_f32_16x16x32_bf16 v[108:111], v[136:139], v[156:159], v[108:111]
    v_mfma_f32_16x16x32_bf16 v[112:115], v[136:139], v[160:163], v[112:115]
    v_mfma_f32_16x16x32_bf16 v[116:119], v[136:139], v[164:167], v[116:119]
    v_mfma_f32_16x16x32_bf16 v[120:123], v[136:139], v[168:171], v[120:123]
    s_waitcnt lgkmcnt(0)
    v_mfma_f32_16x16x32_bf16 v[60:63], v[140:143], v[172:175], v[60:63]
    v_mfma_f32_16x16x32_bf16 v[64:67], v[140:143], v[176:179], v[64:67]
    v_mfma_f32_16x16x32_bf16 v[68:71], v[140:143], v[180:183], v[68:71]
    v_mfma_f32_16x16x32_bf16 v[72:75], v[140:143], v[184:187], v[72:75]
    v_mfma_f32_16x16x32_bf16 v[76:79], v[144:147], v[172:175], v[76:79]
    v_mfma_f32_16x16x32_bf16 v[80:83], v[144:147], v[176:179], v[80:83]
    v_mfma_f32_16x16x32_bf16 v[84:87], v[144:147], v[180:183], v[84:87]
    v_mfma_f32_16x16x32_bf16 v[88:91], v[144:147], v[184:187], v[88:91]
    v_mfma_f32_16x16x32_bf16 v[92:95], v[148:151], v[172:175], v[92:95]
    v_mfma_f32_16x16x32_bf16 v[96:99], v[148:151], v[176:179], v[96:99]
    v_mfma_f32_16x16x32_bf16 v[100:103], v[148:151], v[180:183], v[100:103]
    v_mfma_f32_16x16x32_bf16 v[104:107], v[148:151], v[184:187], v[104:107]
    v_mfma_f32_16x16x32_bf16 v[108:111], v[152:155], v[172:175], v[108:111]
    v_mfma_f32_16x16x32_bf16 v[112:115], v[152:155], v[176:179], v[112:115]
    v_mfma_f32_16x16x32_bf16 v[116:119], v[152:155], v[180:183], v[116:119]
    v_mfma_f32_16x16x32_bf16 v[120:123], v[152:155], v[184:187], v[120:123]
    s_waitcnt vmcnt(0)
    ds_read_b64_tr_b16 v[124:125], v49 offset:0
    ds_read_b64_tr_b16 v[126:127], v49 offset:512
    ds_read_b64_tr_b16 v[128:129], v50 offset:0
    ds_read_b64_tr_b16 v[130:131], v50 offset:512
    ds_read_b64_tr_b16 v[132:133], v51 offset:0
    ds_read_b64_tr_b16 v[134:135], v51 offset:512
    ds_read_b64_tr_b16 v[136:137], v52 offset:0
    ds_read_b64_tr_b16 v[138:139], v52 offset:512
    ds_read_b128 v[156:159], v55 offset:8192
    ds_read_b128 v[160:163], v55 offset:10240
    ds_read_b128 v[164:167], v55 offset:12288
    ds_read_b128 v[168:171], v55 offset:14336
    ds_read_b64_tr_b16 v[140:141], v49 offset:4096
    ds_read_b64_tr_b16 v[142:143], v49 offset:4608
    ds_read_b64_tr_b16 v[144:145], v50 offset:4096
    ds_read_b64_tr_b16 v[146:147], v50 offset:4608
    ds_read_b64_tr_b16 v[148:149], v51 offset:4096
    ds_read_b64_tr_b16 v[150:151], v51 offset:4608
    ds_read_b64_tr_b16 v[152:153], v52 offset:4096
    ds_read_b64_tr_b16 v[154:155], v52 offset:4608
    ds_read_b128 v[172:175], v56 offset:8192
    ds_read_b128 v[176:179], v56 offset:10240
    ds_read_b128 v[180:183], v56 offset:12288
    ds_read_b128 v[184:187], v56 offset:14336
    s_waitcnt lgkmcnt(12)
    v_mfma_f32_16x16x32_bf16 v[60:63], v[124:127], v[156:159], v[60:63]
    v_mfma_f32_16x16x32_bf16 v[64:67], v[124:127], v[160:163], v[64:67]
    v_mfma_f32_16x16x32_bf16 v[68:71], v[124:127], v[164:167], v[68:71]
    v_mfma_f32_16x16x32_bf16 v[72:75], v[124:127], v[168:171], v[72:75]
    v_mfma_f32_16x16x32_bf16 v[76:79], v[128:131], v[156:159], v[76:79]
    v_mfma_f32_16x16x32_bf16 v[80:83], v[128:131], v[160:163], v[80:83]
    v_mfma_f32_16x16x32_bf16 v[84:87], v[128:131], v[164:167], v[84:87]
    v_mfma_f32_16x16x32_bf16 v[88:91], v[128:131], v[168:171], v[88:91]
    v_mfma_f32_16x16x32_bf16 v[92:95], v[132:135], v[156:159], v[92:95]
    v_mfma_f32_16x16x32_bf16 v[96:99], v[132:135], v[160:163], v[96:99]
    v_mfma_f32_16x16x32_bf16 v[100:103], v[132:135], v[164:167], v[100:103]
    v_mfma_f32_16x16x32_bf16 v[104:107], v[132:135], v[168:171], v[104:107]
    v_mfma_f32_16x16x32_bf16 v[108:111], v[136:139], v[156:159], v[108:111]
    v_mfma_f32_16x16x32_bf16 v[112:115], v[136:139], v[160:163], v[112:115]
    v_mfma_f32_16x16x32_bf16 v[116:119], v[136:139], v[164:167], v[116:119]
    v_mfma_f32_16x16x32_bf16 v[120:123], v[136:139], v[168:171], v[120:123]
    s_waitcnt lgkmcnt(0)
    v_mfma_f32_16x16x32_bf16 v[60:63], v[140:143], v[172:175], v[60:63]
    v_mfma_f32_16x16x32_bf16 v[64:67], v[140:143], v[176:179], v[64:67]
    v_mfma_f32_16x16x32_bf16 v[68:71], v[140:143], v[180:183], v[68:71]
    v_mfma_f32_16x16x32_bf16 v[72:75], v[140:143], v[184:187], v[72:75]
    v_mfma_f32_16x16x32_bf16 v[76:79], v[144:147], v[172:175], v[76:79]
    v_mfma_f32_16x16x32_bf16 v[80:83], v[144:147], v[176:179], v[80:83]
    v_mfma_f32_16x16x32_bf16 v[84:87], v[144:147], v[180:183], v[84:87]
    v_mfma_f32_16x16x32_bf16 v[88:91], v[144:147], v[184:187], v[88:91]
    v_mfma_f32_16x16x32_bf16 v[92:95], v[148:151], v[172:175], v[92:95]
    v_mfma_f32_16x16x32_bf16 v[96:99], v[148:151], v[176:179], v[96:99]
    v_mfma_f32_16x16x32_bf16 v[100:103], v[148:151], v[180:183], v[100:103]
    v_mfma_f32_16x16x32_bf16 v[104:107], v[148:151], v[184:187], v[104:107]
    v_mfma_f32_16x16x32_bf16 v[108:111], v[152:155], v[172:175], v[108:111]
    v_mfma_f32_16x16x32_bf16 v[112:115], v[152:155], v[176:179], v[112:115]
    v_mfma_f32_16x16x32_bf16 v[116:119], v[152:155], v[180:183], v[116:119]
    v_mfma_f32_16x16x32_bf16 v[120:123], v[152:155], v[184:187], v[120:123]
    v_lshlrev_b32 v5, 8, v3
    v_add_u32 v5, s68, v5
    v_add_u32 v6, 0, v4
    v_xor_b32 v6, v6, v3
    v_lshl_add_u32 v220, v6, 4, v5
    v_add_u32 v6, 4, v4
    v_xor_b32 v6, v6, v3
    v_lshl_add_u32 v221, v6, 4, v5
    v_add_u32 v6, 8, v4
    v_xor_b32 v6, v6, v3
    v_lshl_add_u32 v222, v6, 4, v5
    v_add_u32 v6, 12, v4
    v_xor_b32 v6, v6, v3
    v_lshl_add_u32 v223, v6, 4, v5
    ds_write_b128 v220, v[60:63] offset:0
    ds_write_b128 v220, v[64:67] offset:4096
    ds_write_b128 v220, v[68:71] offset:8192
    ds_write_b128 v220, v[72:75] offset:12288
    ds_write_b128 v221, v[76:79] offset:0
    ds_write_b128 v221, v[80:83] offset:4096
    ds_write_b128 v221, v[84:87] offset:8192
    ds_write_b128 v221, v[88:91] offset:12288
    ds_write_b128 v222, v[92:95] offset:0
    ds_write_b128 v222, v[96:99] offset:4096
    ds_write_b128 v222, v[100:103] offset:8192
    ds_write_b128 v222, v[104:107] offset:12288
    ds_write_b128 v223, v[108:111] offset:0
    ds_write_b128 v223, v[112:115] offset:4096
    ds_write_b128 v223, v[116:119] offset:8192
    ds_write_b128 v223, v[120:123] offset:12288
    ds_write_b128 v48, v[40:43]
    ds_write_b128 v48, v[44:47] offset:16
    v_lshrrev_b32 v5, 2, v0
    v_and_b32 v6, 3, v0
    v_and_b32 v7, 15, v5
    v_lshl_add_u32 v220, v6, 2, 0
    v_xor_b32 v220, v220, v7
    v_lshlrev_b32 v220, 4, v220
    v_lshl_add_u32 v220, v5, 8, v220
    v_lshl_add_u32 v221, v6, 2, 1
    v_xor_b32 v221, v221, v7
    v_lshlrev_b32 v221, 4, v221
    v_lshl_add_u32 v221, v5, 8, v221
    v_lshl_add_u32 v222, v6, 2, 2
    v_xor_b32 v222, v222, v7
    v_lshlrev_b32 v222, 4, v222
    v_lshl_add_u32 v222, v5, 8, v222
    v_lshl_add_u32 v223, v6, 2, 3
    v_xor_b32 v223, v223, v7
    v_lshlrev_b32 v223, 4, v223
    v_lshl_add_u32 v223, v5, 8, v223
    s_waitcnt lgkmcnt(0)
    s_barrier
    v_add_u32 v224, 65536, v220
    v_add_u32 v225, 65536, v221
    v_add_u32 v226, 65536, v222
    v_add_u32 v227, 65536, v223
    ds_read_b128 v[156:159], v220 offset:0
    ds_read_b128 v[160:163], v221 offset:0
    ds_read_b128 v[164:167], v222 offset:0
    ds_read_b128 v[168:171], v223 offset:0
    ds_read_b128 v[172:175], v220 offset:32768
    ds_read_b128 v[176:179], v221 offset:32768
    ds_read_b128 v[180:183], v222 offset:32768
    ds_read_b128 v[184:187], v223 offset:32768
    ds_read_b128 v[188:191], v224 offset:0
    ds_read_b128 v[192:195], v225 offset:0
    ds_read_b128 v[196:199], v226 offset:0
    ds_read_b128 v[200:203], v227 offset:0
    ds_read_b128 v[204:207], v224 offset:32768
    ds_read_b128 v[208:211], v225 offset:32768
    ds_read_b128 v[212:215], v226 offset:32768
    ds_read_b128 v[216:219], v227 offset:32768
    v_mul_u32_u24 v228, 2304, v6
    v_lshl_add_u32 v228, v5, 1, v228
    v_add_u32 v228, 131072, v228
    ds_read_u16 v124, v228 offset:0
    ds_read_u16 v125, v228 offset:144
    ds_read_u16 v126, v228 offset:288
    ds_read_u16 v127, v228 offset:432
    ds_read_u16 v128, v228 offset:576
    ds_read_u16 v129, v228 offset:720
    ds_read_u16 v130, v228 offset:864
    ds_read_u16 v131, v228 offset:1008
    ds_read_u16 v132, v228 offset:1152
    ds_read_u16 v133, v228 offset:1296
    ds_read_u16 v134, v228 offset:1440
    ds_read_u16 v135, v228 offset:1584
    ds_read_u16 v136, v228 offset:1728
    ds_read_u16 v137, v228 offset:1872
    ds_read_u16 v138, v228 offset:2016
    ds_read_u16 v139, v228 offset:2160
    s_waitcnt lgkmcnt(0)
    s_mov_b32 s73, 0xffff0000
    s_mov_b32 s74, 0xbfb8aa3b
    v_add_f32 v140, v156, v172
    v_add_f32 v144, v188, v204
    v_add_f32 v141, v157, v173
    v_add_f32 v145, v189, v205
    v_add_f32 v142, v158, v174
    v_add_f32 v146, v190, v206
    v_add_f32 v143, v159, v175
    v_add_f32 v147, v191, v207
    v_add_f32 v140, v140, v144
    v_add_f32 v141, v141, v145
    v_add_f32 v142, v142, v146
    v_add_f32 v143, v143, v147
    v_cvt_pk_bf16_f32 v141, v140, v141
    v_lshlrev_b32 v140, 16, v141
    v_and_b32 v141, s73, v141
    v_cvt_pk_bf16_f32 v143, v142, v143
    v_lshlrev_b32 v142, 16, v143
    v_and_b32 v143, s73, v143
    v_mul_f32 v144, s74, v140
    v_mul_f32 v145, s74, v141
    v_mul_f32 v146, s74, v142
    v_mul_f32 v147, s74, v143
    v_exp_f32 v144, v144
    v_exp_f32 v145, v145
    v_exp_f32 v146, v146
    v_exp_f32 v147, v147
    v_add_f32 v144, 1.0, v144
    v_add_f32 v145, 1.0, v145
    v_add_f32 v146, 1.0, v146
    v_add_f32 v147, 1.0, v147
    v_rcp_f32 v144, v144
    v_rcp_f32 v145, v145
    v_rcp_f32 v146, v146
    v_rcp_f32 v147, v147
    v_mul_f32 v144, v144, v140
    v_mul_f32 v145, v145, v141
    v_mul_f32 v146, v146, v142
    v_mul_f32 v147, v147, v143
    v_cvt_pk_bf16_f32 v145, v144, v145
    v_lshlrev_b32 v144, 16, v145
    v_and_b32 v145, s73, v145
    v_cvt_pk_bf16_f32 v147, v146, v147
    v_lshlrev_b32 v146, 16, v147
    v_and_b32 v147, s73, v147
    v_lshlrev_b32 v148, 16, v24
    v_and_b32 v149, s73, v24
    v_lshlrev_b32 v152, 16, v32
    v_and_b32 v153, s73, v32
    v_lshlrev_b32 v150, 16, v25
    v_and_b32 v151, s73, v25
    v_lshlrev_b32 v154, 16, v33
    v_and_b32 v155, s73, v33
    v_mul_f32 v148, v148, v152
    v_mul_f32 v149, v149, v153
    v_mul_f32 v150, v150, v154
    v_mul_f32 v151, v151, v155
    v_cvt_pk_bf16_f32 v149, v148, v149
    v_lshlrev_b32 v148, 16, v149
    v_and_b32 v149, s73, v149
    v_cvt_pk_bf16_f32 v151, v150, v151
    v_lshlrev_b32 v150, 16, v151
    v_and_b32 v151, s73, v151
    v_lshlrev_b32 v152, 16, v124
    v_lshlrev_b32 v153, 16, v125
    v_lshlrev_b32 v154, 16, v126
    v_lshlrev_b32 v155, 16, v127
    v_add_f32 v148, v148, v152
    v_add_f32 v149, v149, v153
    v_add_f32 v150, v150, v154
    v_add_f32 v151, v151, v155
    v_cvt_pk_bf16_f32 v149, v148, v149
    v_lshlrev_b32 v148, 16, v149
    v_and_b32 v149, s73, v149
    v_cvt_pk_bf16_f32 v151, v150, v151
    v_lshlrev_b32 v150, 16, v151
    v_and_b32 v151, s73, v151
    v_mul_f32 v148, v148, v144
    v_mul_f32 v149, v149, v145
    v_mul_f32 v150, v150, v146
    v_mul_f32 v151, v151, v147
    v_cvt_pk_bf16_f32 v149, v148, v149
    v_lshlrev_b32 v148, 16, v149
    v_and_b32 v149, s73, v149
    v_cvt_pk_bf16_f32 v151, v150, v151
    v_lshlrev_b32 v150, 16, v151
    v_and_b32 v151, s73, v151
    v_lshlrev_b32 v152, 16, v16
    v_and_b32 v153, s73, v16
    v_lshlrev_b32 v154, 16, v17
    v_and_b32 v155, s73, v17
    v_add_f32 v148, v148, v152
    v_add_f32 v149, v149, v153
    v_add_f32 v150, v150, v154
    v_add_f32 v151, v151, v155
    v_cvt_pk_bf16_f32 v40, v148, v149
    v_cvt_pk_bf16_f32 v41, v150, v151
    v_add_f32 v140, v160, v176
    v_add_f32 v144, v192, v208
    v_add_f32 v141, v161, v177
    v_add_f32 v145, v193, v209
    v_add_f32 v142, v162, v178
    v_add_f32 v146, v194, v210
    v_add_f32 v143, v163, v179
    v_add_f32 v147, v195, v211
    v_add_f32 v140, v140, v144
    v_add_f32 v141, v141, v145
    v_add_f32 v142, v142, v146
    v_add_f32 v143, v143, v147
    v_cvt_pk_bf16_f32 v141, v140, v141
    v_lshlrev_b32 v140, 16, v141
    v_and_b32 v141, s73, v141
    v_cvt_pk_bf16_f32 v143, v142, v143
    v_lshlrev_b32 v142, 16, v143
    v_and_b32 v143, s73, v143
    v_mul_f32 v144, s74, v140
    v_mul_f32 v145, s74, v141
    v_mul_f32 v146, s74, v142
    v_mul_f32 v147, s74, v143
    v_exp_f32 v144, v144
    v_exp_f32 v145, v145
    v_exp_f32 v146, v146
    v_exp_f32 v147, v147
    v_add_f32 v144, 1.0, v144
    v_add_f32 v145, 1.0, v145
    v_add_f32 v146, 1.0, v146
    v_add_f32 v147, 1.0, v147
    v_rcp_f32 v144, v144
    v_rcp_f32 v145, v145
    v_rcp_f32 v146, v146
    v_rcp_f32 v147, v147
    v_mul_f32 v144, v144, v140
    v_mul_f32 v145, v145, v141
    v_mul_f32 v146, v146, v142
    v_mul_f32 v147, v147, v143
    v_cvt_pk_bf16_f32 v145, v144, v145
    v_lshlrev_b32 v144, 16, v145
    v_and_b32 v145, s73, v145
    v_cvt_pk_bf16_f32 v147, v146, v147
    v_lshlrev_b32 v146, 16, v147
    v_and_b32 v147, s73, v147
    v_lshlrev_b32 v148, 16, v26
    v_and_b32 v149, s73, v26
    v_lshlrev_b32 v152, 16, v34
    v_and_b32 v153, s73, v34
    v_lshlrev_b32 v150, 16, v27
    v_and_b32 v151, s73, v27
    v_lshlrev_b32 v154, 16, v35
    v_and_b32 v155, s73, v35
    v_mul_f32 v148, v148, v152
    v_mul_f32 v149, v149, v153
    v_mul_f32 v150, v150, v154
    v_mul_f32 v151, v151, v155
    v_cvt_pk_bf16_f32 v149, v148, v149
    v_lshlrev_b32 v148, 16, v149
    v_and_b32 v149, s73, v149
    v_cvt_pk_bf16_f32 v151, v150, v151
    v_lshlrev_b32 v150, 16, v151
    v_and_b32 v151, s73, v151
    v_lshlrev_b32 v152, 16, v128
    v_lshlrev_b32 v153, 16, v129
    v_lshlrev_b32 v154, 16, v130
    v_lshlrev_b32 v155, 16, v131
    v_add_f32 v148, v148, v152
    v_add_f32 v149, v149, v153
    v_add_f32 v150, v150, v154
    v_add_f32 v151, v151, v155
    v_cvt_pk_bf16_f32 v149, v148, v149
    v_lshlrev_b32 v148, 16, v149
    v_and_b32 v149, s73, v149
    v_cvt_pk_bf16_f32 v151, v150, v151
    v_lshlrev_b32 v150, 16, v151
    v_and_b32 v151, s73, v151
    v_mul_f32 v148, v148, v144
    v_mul_f32 v149, v149, v145
    v_mul_f32 v150, v150, v146
    v_mul_f32 v151, v151, v147
    v_cvt_pk_bf16_f32 v149, v148, v149
    v_lshlrev_b32 v148, 16, v149
    v_and_b32 v149, s73, v149
    v_cvt_pk_bf16_f32 v151, v150, v151
    v_lshlrev_b32 v150, 16, v151
    v_and_b32 v151, s73, v151
    v_lshlrev_b32 v152, 16, v18
    v_and_b32 v153, s73, v18
    v_lshlrev_b32 v154, 16, v19
    v_and_b32 v155, s73, v19
    v_add_f32 v148, v148, v152
    v_add_f32 v149, v149, v153
    v_add_f32 v150, v150, v154
    v_add_f32 v151, v151, v155
    v_cvt_pk_bf16_f32 v42, v148, v149
    v_cvt_pk_bf16_f32 v43, v150, v151
    v_add_f32 v140, v164, v180
    v_add_f32 v144, v196, v212
    v_add_f32 v141, v165, v181
    v_add_f32 v145, v197, v213
    v_add_f32 v142, v166, v182
    v_add_f32 v146, v198, v214
    v_add_f32 v143, v167, v183
    v_add_f32 v147, v199, v215
    v_add_f32 v140, v140, v144
    v_add_f32 v141, v141, v145
    v_add_f32 v142, v142, v146
    v_add_f32 v143, v143, v147
    v_cvt_pk_bf16_f32 v141, v140, v141
    v_lshlrev_b32 v140, 16, v141
    v_and_b32 v141, s73, v141
    v_cvt_pk_bf16_f32 v143, v142, v143
    v_lshlrev_b32 v142, 16, v143
    v_and_b32 v143, s73, v143
    v_mul_f32 v144, s74, v140
    v_mul_f32 v145, s74, v141
    v_mul_f32 v146, s74, v142
    v_mul_f32 v147, s74, v143
    v_exp_f32 v144, v144
    v_exp_f32 v145, v145
    v_exp_f32 v146, v146
    v_exp_f32 v147, v147
    v_add_f32 v144, 1.0, v144
    v_add_f32 v145, 1.0, v145
    v_add_f32 v146, 1.0, v146
    v_add_f32 v147, 1.0, v147
    v_rcp_f32 v144, v144
    v_rcp_f32 v145, v145
    v_rcp_f32 v146, v146
    v_rcp_f32 v147, v147
    v_mul_f32 v144, v144, v140
    v_mul_f32 v145, v145, v141
    v_mul_f32 v146, v146, v142
    v_mul_f32 v147, v147, v143
    v_cvt_pk_bf16_f32 v145, v144, v145
    v_lshlrev_b32 v144, 16, v145
    v_and_b32 v145, s73, v145
    v_cvt_pk_bf16_f32 v147, v146, v147
    v_lshlrev_b32 v146, 16, v147
    v_and_b32 v147, s73, v147
    v_lshlrev_b32 v148, 16, v28
    v_and_b32 v149, s73, v28
    v_lshlrev_b32 v152, 16, v36
    v_and_b32 v153, s73, v36
    v_lshlrev_b32 v150, 16, v29
    v_and_b32 v151, s73, v29
    v_lshlrev_b32 v154, 16, v37
    v_and_b32 v155, s73, v37
    v_mul_f32 v148, v148, v152
    v_mul_f32 v149, v149, v153
    v_mul_f32 v150, v150, v154
    v_mul_f32 v151, v151, v155
    v_cvt_pk_bf16_f32 v149, v148, v149
    v_lshlrev_b32 v148, 16, v149
    v_and_b32 v149, s73, v149
    v_cvt_pk_bf16_f32 v151, v150, v151
    v_lshlrev_b32 v150, 16, v151
    v_and_b32 v151, s73, v151
    v_lshlrev_b32 v152, 16, v132
    v_lshlrev_b32 v153, 16, v133
    v_lshlrev_b32 v154, 16, v134
    v_lshlrev_b32 v155, 16, v135
    v_add_f32 v148, v148, v152
    v_add_f32 v149, v149, v153
    v_add_f32 v150, v150, v154
    v_add_f32 v151, v151, v155
    v_cvt_pk_bf16_f32 v149, v148, v149
    v_lshlrev_b32 v148, 16, v149
    v_and_b32 v149, s73, v149
    v_cvt_pk_bf16_f32 v151, v150, v151
    v_lshlrev_b32 v150, 16, v151
    v_and_b32 v151, s73, v151
    v_mul_f32 v148, v148, v144
    v_mul_f32 v149, v149, v145
    v_mul_f32 v150, v150, v146
    v_mul_f32 v151, v151, v147
    v_cvt_pk_bf16_f32 v149, v148, v149
    v_lshlrev_b32 v148, 16, v149
    v_and_b32 v149, s73, v149
    v_cvt_pk_bf16_f32 v151, v150, v151
    v_lshlrev_b32 v150, 16, v151
    v_and_b32 v151, s73, v151
    v_lshlrev_b32 v152, 16, v20
    v_and_b32 v153, s73, v20
    v_lshlrev_b32 v154, 16, v21
    v_and_b32 v155, s73, v21
    v_add_f32 v148, v148, v152
    v_add_f32 v149, v149, v153
    v_add_f32 v150, v150, v154
    v_add_f32 v151, v151, v155
    v_cvt_pk_bf16_f32 v44, v148, v149
    v_cvt_pk_bf16_f32 v45, v150, v151
    v_add_f32 v140, v168, v184
    v_add_f32 v144, v200, v216
    v_add_f32 v141, v169, v185
    v_add_f32 v145, v201, v217
    v_add_f32 v142, v170, v186
    v_add_f32 v146, v202, v218
    v_add_f32 v143, v171, v187
    v_add_f32 v147, v203, v219
    v_add_f32 v140, v140, v144
    v_add_f32 v141, v141, v145
    v_add_f32 v142, v142, v146
    v_add_f32 v143, v143, v147
    v_cvt_pk_bf16_f32 v141, v140, v141
    v_lshlrev_b32 v140, 16, v141
    v_and_b32 v141, s73, v141
    v_cvt_pk_bf16_f32 v143, v142, v143
    v_lshlrev_b32 v142, 16, v143
    v_and_b32 v143, s73, v143
    v_mul_f32 v144, s74, v140
    v_mul_f32 v145, s74, v141
    v_mul_f32 v146, s74, v142
    v_mul_f32 v147, s74, v143
    v_exp_f32 v144, v144
    v_exp_f32 v145, v145
    v_exp_f32 v146, v146
    v_exp_f32 v147, v147
    v_add_f32 v144, 1.0, v144
    v_add_f32 v145, 1.0, v145
    v_add_f32 v146, 1.0, v146
    v_add_f32 v147, 1.0, v147
    v_rcp_f32 v144, v144
    v_rcp_f32 v145, v145
    v_rcp_f32 v146, v146
    v_rcp_f32 v147, v147
    v_mul_f32 v144, v144, v140
    v_mul_f32 v145, v145, v141
    v_mul_f32 v146, v146, v142
    v_mul_f32 v147, v147, v143
    v_cvt_pk_bf16_f32 v145, v144, v145
    v_lshlrev_b32 v144, 16, v145
    v_and_b32 v145, s73, v145
    v_cvt_pk_bf16_f32 v147, v146, v147
    v_lshlrev_b32 v146, 16, v147
    v_and_b32 v147, s73, v147
    v_lshlrev_b32 v148, 16, v30
    v_and_b32 v149, s73, v30
    v_lshlrev_b32 v152, 16, v38
    v_and_b32 v153, s73, v38
    v_lshlrev_b32 v150, 16, v31
    v_and_b32 v151, s73, v31
    v_lshlrev_b32 v154, 16, v39
    v_and_b32 v155, s73, v39
    v_mul_f32 v148, v148, v152
    v_mul_f32 v149, v149, v153
    v_mul_f32 v150, v150, v154
    v_mul_f32 v151, v151, v155
    v_cvt_pk_bf16_f32 v149, v148, v149
    v_lshlrev_b32 v148, 16, v149
    v_and_b32 v149, s73, v149
    v_cvt_pk_bf16_f32 v151, v150, v151
    v_lshlrev_b32 v150, 16, v151
    v_and_b32 v151, s73, v151
    v_lshlrev_b32 v152, 16, v136
    v_lshlrev_b32 v153, 16, v137
    v_lshlrev_b32 v154, 16, v138
    v_lshlrev_b32 v155, 16, v139
    v_add_f32 v148, v148, v152
    v_add_f32 v149, v149, v153
    v_add_f32 v150, v150, v154
    v_add_f32 v151, v151, v155
    v_cvt_pk_bf16_f32 v149, v148, v149
    v_lshlrev_b32 v148, 16, v149
    v_and_b32 v149, s73, v149
    v_cvt_pk_bf16_f32 v151, v150, v151
    v_lshlrev_b32 v150, 16, v151
    v_and_b32 v151, s73, v151
    v_mul_f32 v148, v148, v144
    v_mul_f32 v149, v149, v145
    v_mul_f32 v150, v150, v146
    v_mul_f32 v151, v151, v147
    v_cvt_pk_bf16_f32 v149, v148, v149
    v_lshlrev_b32 v148, 16, v149
    v_and_b32 v149, s73, v149
    v_cvt_pk_bf16_f32 v151, v150, v151
    v_lshlrev_b32 v150, 16, v151
    v_and_b32 v151, s73, v151
    v_lshlrev_b32 v152, 16, v22
    v_and_b32 v153, s73, v22
    v_lshlrev_b32 v154, 16, v23
    v_and_b32 v155, s73, v23
    v_add_f32 v148, v148, v152
    v_add_f32 v149, v149, v153
    v_add_f32 v150, v150, v154
    v_add_f32 v151, v151, v155
    v_cvt_pk_bf16_f32 v46, v148, v149
    v_cvt_pk_bf16_f32 v47, v150, v151
    buffer_store_dwordx4 v[40:43], v11, s[60:63], 0 offen
    buffer_store_dwordx4 v[44:47], v11, s[60:63], 0 offen offset:16
    s_waitcnt vmcnt(0)
K4_END:
    s_endpgm
.section .rodata,"a"
.p2align 6
.amdhsa_kernel k1_kernel
  .amdhsa_next_free_vgpr 81
  .amdhsa_next_free_sgpr 68
  .amdhsa_accum_offset 84
  .amdhsa_group_segment_fixed_size 0
  .amdhsa_kernarg_size 112
  .amdhsa_user_sgpr_count 2
  .amdhsa_user_sgpr_kernarg_segment_ptr 1
  .amdhsa_system_sgpr_workgroup_id_x 1
  .amdhsa_float_denorm_mode_32 3
.end_amdhsa_kernel
.p2align 6
.amdhsa_kernel k23_kernel
  .amdhsa_next_free_vgpr 224
  .amdhsa_next_free_sgpr 70
  .amdhsa_accum_offset 224
  .amdhsa_group_segment_fixed_size 0
  .amdhsa_kernarg_size 112
  .amdhsa_user_sgpr_count 2
  .amdhsa_user_sgpr_kernarg_segment_ptr 1
  .amdhsa_system_sgpr_workgroup_id_x 1
  .amdhsa_float_denorm_mode_32 3
.end_amdhsa_kernel
.p2align 6
.amdhsa_kernel k4_kernel
  .amdhsa_next_free_vgpr 229
  .amdhsa_next_free_sgpr 75
  .amdhsa_accum_offset 232
  .amdhsa_group_segment_fixed_size 0
  .amdhsa_kernarg_size 112
  .amdhsa_user_sgpr_count 2
  .amdhsa_user_sgpr_kernarg_segment_ptr 1
  .amdhsa_system_sgpr_workgroup_id_x 1
  .amdhsa_float_denorm_mode_32 3
.end_amdhsa_kernel
```
